```python
import torch

def _softmax(x, axis=-1):
    return torch.softmax(x, dim=axis)
def _gelu(x):
    return torch.nn.functional.gelu(x, approximate="tanh")
def _silu(x):
    return torch.nn.functional.silu(x)
def _sigmoid(x):
    return torch.sigmoid(x)
def _layernorm(x, axis=-1, eps=1e-5):
    m = x.mean(dim=axis, keepdim=True)
    v = x.var(dim=axis, keepdim=True, unbiased=False)
    return (x - m) / torch.sqrt(v + eps)
def _scatter_add(tgt, idx, src, axis=0):
    return tgt.clone().index_add_(axis, idx, src)
def _segment_sum(src, seg, n):
    out = torch.zeros((n,) + src.shape[1:], dtype=src.dtype)
    return out.index_add_(0, seg, src)
def _pad(x, pw):
    flat = tuple(v for pair in reversed(pw) for v in pair)
    return torch.nn.functional.pad(x, flat)

kernel_name = 'sequential_preLN__ssm_conv_s4d__glu_gated_geglu__prompt'

def setup_inputs():

    _w = (lambda a: (lambda t: t.to(torch.bfloat16) if t.is_floating_point() else t)(torch.as_tensor(a)))
    def _A_setup():
        Bsz, L, D, N = 1, 2048, 512, 128
        return {
            "u": _w((lambda *s: torch.randn(*s, dtype=torch.bfloat16) * 0.05)(Bsz, L, D)),
            "log_A_real": _w((lambda *s: torch.randn(*s, dtype=torch.bfloat16) * 6.4)(D, N) * 0.5),
            "A_imag": _w((lambda *s: torch.randn(*s, dtype=torch.bfloat16) * 0.05)(D, N) * 3.14),
            "C_real": _w((lambda *s: torch.randn(*s, dtype=torch.bfloat16) * 0.05)(D, N) / N ** 0.5),
            "C_imag": _w((lambda *s: torch.randn(*s, dtype=torch.bfloat16) * 0.05)(D, N) / N ** 0.5),
            "log_dt": _w((lambda *s: torch.randn(*s, dtype=torch.bfloat16) * 0.05)(D) * 0.5 - 4.0),
            "D_skip": _w((lambda *s: torch.randn(*s, dtype=torch.bfloat16) * 0.05)(D)),
        }
    _A_in = _A_setup()

    def _B_setup():
        B, S, Dm, Df = 1, 2048, 512, 1792
        return {
            "x": _w((lambda *s: torch.randn(*s, dtype=torch.bfloat16) * 0.05)(B, S, Dm)),
            "w_gate": _w((lambda *s: torch.randn(*s, dtype=torch.bfloat16) * 0.4)(Dm, Df) * (Dm ** -0.5)),
            "w_up": _w((lambda *s: torch.randn(*s, dtype=torch.bfloat16) * 0.4)(Dm, Df) * (Dm ** -0.5)),
            "w_down": _w((lambda *s: torch.randn(*s, dtype=torch.bfloat16) * 0.4)(Df, Dm) * (Df ** -0.5)),
        }
    _B_in = _B_setup()

    return {
        "A_u": _A_in["u"],
        "A_log_A_real": _A_in["log_A_real"],
        "A_A_imag": _A_in["A_imag"],
        "A_C_real": _A_in["C_real"],
        "A_C_imag": _A_in["C_imag"],
        "A_log_dt": _A_in["log_dt"],
        "A_D_skip": _A_in["D_skip"],
        "B_x": _B_in["x"],
        "B_w_gate": _B_in["w_gate"],
        "B_w_up": _B_in["w_up"],
        "B_w_down": _B_in["w_down"],
    }

def reference(A_u, A_log_A_real, A_A_imag, A_C_real, A_C_imag, A_log_dt, A_D_skip, B_x, B_w_gate, B_w_up, B_w_down):
    def _A_ref(u, log_A_real, A_imag, C_real, C_imag, log_dt, D_skip):
        L = u.shape[1]
        dt = torch.exp(log_dt)
        A = -torch.exp(log_A_real) + 1j * A_imag
        C = (C_real + 1j * C_imag) * dt[:, None]
        pos = (lambda x, dt: x.to(dt))(torch.arange(L), log_dt.dtype)
        P = torch.exp((A * dt[:, None])[:, :, None] * pos[None, None, :])
        K = 2.0 * torch.einsum("dn,dnl->dl", C, P).real
        L2 = 2 * L
        u_t = (lambda x, *d: x.permute(*d))(u, 0, 2, 1)
        Kf = (lambda x, *a, **k: torch.fft.rfft(x.float(), *a, **k))(K, L2)
        Uf = (lambda x, *a, **k: torch.fft.rfft(x.float(), *a, **k))(u_t, L2)
        y = (lambda x, *a, **k: torch.fft.irfft(x, *a, **k).to(torch.bfloat16))(Uf * Kf[None, :, :], L2)[:, :, :L]
        y = (lambda x, *d: x.permute(*d))(y, 0, 2, 1)
        return y + u * D_skip[None, None, :]

    def _B_ref(x, w_gate, w_up, w_down):
        g = torch.einsum("bsd,df->bsf", x, w_gate)
        u = torch.einsum("bsd,df->bsf", x, w_up)
        h = _gelu(g) * u
        return torch.einsum("bsf,fd->bsd", h, w_down)

    x = A_u
    h = x + _A_ref(_layernorm(x, axis=-1), A_log_A_real, A_A_imag, A_C_real, A_C_imag, A_log_dt, A_D_skip)
    h2 = h + _B_ref(_layernorm(h, axis=-1), B_w_gate, B_w_up, B_w_down)
    return h2
```

```asm
; @launch kernel=ka_ssm_kernel grid=(256,1,1) block=(1024,1,1) lds=130496
; @launch kernel=kb_mlp_kernel grid=(256,1,1) block=(512,1,1) lds=133248
.amdgcn_target "amdgcn-amd-amdhsa--gfx950"
.text
.p2align 8
CODE_START:
.globl ka_ssm_kernel
.p2align 8
.type ka_ssm_kernel,@function
ka_ssm_kernel:
    s_load_dwordx16 s[16:31], s[0:1], 0
    s_load_dwordx8 s[32:39], s[0:1], 64
    s_load_dwordx4 s[40:43], s[0:1], 96
    v_lshrrev_b32 v1, 6, v0
    v_and_b32 v2, 63, v0
    v_readfirstlane_b32 s3, v1
    s_cmp_ge_u32 s2, 256
    s_nop 3
    s_cbranch_scc1 KA_END
    s_and_b32 s4, s2, 7
    s_lshl_b32 s4, s4, 5
    s_lshr_b32 s5, s2, 3
    s_add_u32 s4, s4, s5
    v_lshrrev_b32 v120, 4, v2
    v_and_b32 v121, 15, v2
    v_lshlrev_b32 v3, 4, v2
    s_lshr_b32 s79, s3, 3
    s_xor_b32 s79, s79, 1
    s_and_b32 s3, s3, 7
    v_and_b32 v0, 0x1ff, v0
    s_cmp_eq_u32 s79, 1
    s_nop 1
    s_cbranch_scc1 KA_LG
    v_lshlrev_b32 v4, 2, v2
    s_lshr_b32 s8, s3, 2
    s_lshl_b32 s7, s4, 1
    s_add_u32 s6, s8, s7
    s_lshl_b32 s7, s6, 8
    s_and_b32 s9, s3, 3
    s_lshl_b32 s10, s6, 1
    v_mov_b32 v5, s10
    s_waitcnt lgkmcnt(0)
    s_mov_b32 s48, s18
    s_and_b32 s49, s19, 0xffff
    s_mov_b32 s50, 131072
    s_mov_b32 s51, 0x00020000
    buffer_load_dword v12, v4, s[48:51], s7 offen
    s_mov_b32 s52, s26
    s_and_b32 s53, s27, 0xffff
    s_mov_b32 s54, 1024
    s_mov_b32 s55, 0x00020000
    buffer_load_ushort v16, v5, s[52:55], 0 offen
    s_mov_b32 s56, s20
    s_and_b32 s57, s21, 0xffff
    s_mov_b32 s58, 131072
    s_mov_b32 s59, 0x00020000
    buffer_load_dword v13, v4, s[56:59], s7 offen
    s_mov_b32 s60, s22
    s_and_b32 s61, s23, 0xffff
    s_mov_b32 s62, 131072
    s_mov_b32 s63, 0x00020000
    buffer_load_dword v14, v4, s[60:63], s7 offen
    s_mov_b32 s64, s24
    s_and_b32 s65, s25, 0xffff
    s_mov_b32 s66, 131072
    s_mov_b32 s67, 0x00020000
    buffer_load_dword v15, v4, s[64:67], s7 offen
    s_mov_b32 s68, s42
    s_and_b32 s69, s43, 0xffff
    s_mov_b32 s70, 268435456
    s_mov_b32 s71, 0x00020000
    v_lshrrev_b32 v40, 8, v0
    v_and_b32 v41, 255, v0
    v_lshlrev_b32 v42, 3, v41
    v_sub_u32 v42, 2047, v42
    v_subrev_u32 v104, 0, v42
    v_subrev_u32 v105, 1, v42
    v_subrev_u32 v106, 2, v42
    v_subrev_u32 v107, 3, v42
    v_subrev_u32 v108, 4, v42
    v_subrev_u32 v109, 5, v42
    v_subrev_u32 v110, 6, v42
    v_subrev_u32 v111, 7, v42
    v_subrev_u32 v112, 8, v42
    v_subrev_u32 v113, 9, v42
    v_subrev_u32 v114, 10, v42
    v_subrev_u32 v115, 11, v42
    v_subrev_u32 v116, 12, v42
    v_subrev_u32 v117, 13, v42
    v_subrev_u32 v118, 14, v42
    v_subrev_u32 v119, 15, v42
    v_max_i32 v80, 0, v104
    v_max_i32 v81, 0, v105
    v_max_i32 v82, 0, v106
    v_max_i32 v83, 0, v107
    v_max_i32 v84, 0, v108
    v_max_i32 v85, 0, v109
    v_max_i32 v86, 0, v110
    v_max_i32 v87, 0, v111
    v_max_i32 v88, 0, v112
    v_max_i32 v89, 0, v113
    v_max_i32 v90, 0, v114
    v_max_i32 v91, 0, v115
    v_max_i32 v92, 0, v116
    v_max_i32 v93, 0, v117
    v_max_i32 v94, 0, v118
    v_max_i32 v95, 0, v119
    v_cvt_f32_u32 v80, v80
    v_cvt_f32_u32 v81, v81
    v_cvt_f32_u32 v82, v82
    v_cvt_f32_u32 v83, v83
    v_cvt_f32_u32 v84, v84
    v_cvt_f32_u32 v85, v85
    v_cvt_f32_u32 v86, v86
    v_cvt_f32_u32 v87, v87
    v_cvt_f32_u32 v88, v88
    v_cvt_f32_u32 v89, v89
    v_cvt_f32_u32 v90, v90
    v_cvt_f32_u32 v91, v91
    v_cvt_f32_u32 v92, v92
    v_cvt_f32_u32 v93, v93
    v_cvt_f32_u32 v94, v94
    v_cvt_f32_u32 v95, v95
    v_cvt_pk_bf16_f32 v96, v80, v81
    v_cvt_pk_bf16_f32 v97, v82, v83
    v_cvt_pk_bf16_f32 v98, v84, v85
    v_cvt_pk_bf16_f32 v99, v86, v87
    v_cvt_pk_bf16_f32 v100, v88, v89
    v_cvt_pk_bf16_f32 v101, v90, v91
    v_cvt_pk_bf16_f32 v102, v92, v93
    v_cvt_pk_bf16_f32 v103, v94, v95
    v_and_b32 v80, 0xffff, v96
    v_lshrrev_b32 v81, 16, v96
    v_and_b32 v82, 0xffff, v97
    v_lshrrev_b32 v83, 16, v97
    v_and_b32 v84, 0xffff, v98
    v_lshrrev_b32 v85, 16, v98
    v_and_b32 v86, 0xffff, v99
    v_lshrrev_b32 v87, 16, v99
    v_and_b32 v88, 0xffff, v100
    v_lshrrev_b32 v89, 16, v100
    v_and_b32 v90, 0xffff, v101
    v_lshrrev_b32 v91, 16, v101
    v_and_b32 v92, 0xffff, v102
    v_lshrrev_b32 v93, 16, v102
    v_and_b32 v94, 0xffff, v103
    v_lshrrev_b32 v95, 16, v103
    s_movk_i32 s14, 0x80
    v_subrev_u32 v80, 17024, v80
    v_med3_i32 v104, v104, -1, s14
    v_subrev_u32 v81, 17024, v81
    v_med3_i32 v105, v105, -1, s14
    v_subrev_u32 v82, 17024, v82
    v_med3_i32 v106, v106, -1, s14
    v_subrev_u32 v83, 17024, v83
    v_med3_i32 v107, v107, -1, s14
    v_subrev_u32 v84, 17024, v84
    v_med3_i32 v108, v108, -1, s14
    v_subrev_u32 v85, 17024, v85
    v_med3_i32 v109, v109, -1, s14
    v_subrev_u32 v86, 17024, v86
    v_med3_i32 v110, v110, -1, s14
    v_subrev_u32 v87, 17024, v87
    v_med3_i32 v111, v111, -1, s14
    v_subrev_u32 v88, 17024, v88
    v_med3_i32 v112, v112, -1, s14
    v_subrev_u32 v89, 17024, v89
    v_med3_i32 v113, v113, -1, s14
    v_subrev_u32 v90, 17024, v90
    v_med3_i32 v114, v114, -1, s14
    v_subrev_u32 v91, 17024, v91
    v_med3_i32 v115, v115, -1, s14
    v_subrev_u32 v92, 17024, v92
    v_med3_i32 v116, v116, -1, s14
    v_subrev_u32 v93, 17024, v93
    v_med3_i32 v117, v117, -1, s14
    v_subrev_u32 v94, 17024, v94
    v_med3_i32 v118, v118, -1, s14
    v_max_i32 v104, v104, v80
    v_max_i32 v105, v105, v81
    v_max_i32 v106, v106, v82
    v_max_i32 v107, v107, v83
    v_max_i32 v108, v108, v84
    v_max_i32 v109, v109, v85
    v_max_i32 v110, v110, v86
    v_max_i32 v111, v111, v87
    v_max_i32 v112, v112, v88
    v_max_i32 v113, v113, v89
    v_max_i32 v114, v114, v90
    v_max_i32 v115, v115, v91
    v_max_i32 v116, v116, v92
    v_max_i32 v117, v117, v93
    v_max_i32 v118, v118, v94
    v_mul_u32_u24 v43, 1600, v40
    v_add_u32 v43, 75792, v43
    v_lshl_add_u32 v104, v104, 1, v43
    v_lshl_add_u32 v105, v105, 1, v43
    v_lshl_add_u32 v106, v106, 1, v43
    v_lshl_add_u32 v107, v107, 1, v43
    v_lshl_add_u32 v108, v108, 1, v43
    v_lshl_add_u32 v109, v109, 1, v43
    v_lshl_add_u32 v110, v110, 1, v43
    v_lshl_add_u32 v111, v111, 1, v43
    v_lshl_add_u32 v112, v112, 1, v43
    v_lshl_add_u32 v113, v113, 1, v43
    v_lshl_add_u32 v114, v114, 1, v43
    v_lshl_add_u32 v115, v115, 1, v43
    v_lshl_add_u32 v116, v116, 1, v43
    v_lshl_add_u32 v117, v117, 1, v43
    v_lshl_add_u32 v118, v118, 1, v43
    v_mul_u32_u24 v119, 33280, v40
    v_lshl_add_u32 v119, v41, 4, v119
    v_and_b32 v122, 7, v121
    v_sub_u32 v122, 7, v122
    v_mul_u32_u24 v122, 4160, v122
    v_lshrrev_b32 v123, 3, v121
    v_sub_u32 v123, v120, v123
    v_lshl_add_u32 v122, v123, 4, v122
    s_mul_i32 s12, s8, 33280
    s_lshl_b32 s13, s9, 7
    s_sub_u32 s12, s12, s13
    s_add_u32 s12, s12, 400
    v_add_u32 v122, s12, v122
    v_lshlrev_b32 v123, 5, v121
    v_lshl_add_u32 v123, v120, 4, v123
    s_mul_i32 s12, s8, 4608
    s_sub_u32 s12, s12, s13
    s_add_u32 s12, s12, 66976
    v_add_u32 v123, s12, v123
    s_cmp_ge_u32 s3, 3
    s_cselect_b32 s64, 1, 0
    s_mul_i32 s10, s64, 3
    s_sub_u32 s65, s3, s10
    v_mul_u32_u24 v54, 544, v121
    v_lshl_add_u32 v54, v120, 4, v54
    s_mul_i32 s13, s64, 31008
    s_mul_i32 s10, s65, 8704
    s_add_u32 s10, s10, s13
    v_add_u32 v124, s10, v54
    s_add_u32 s10, s13, 22304
    v_add_u32 v125, s10, v54
    s_mul_i32 s13, s8, 31008
    v_lshlrev_b32 v6, 3, v2
    v_add_u32 v6, s13, v6
    s_waitcnt vmcnt(3)
    v_and_b32 v41, 0xffff0000, v12
    v_lshlrev_b32 v40, 16, v12
    v_lshlrev_b32 v42, 16, v16
    v_mul_f32 v50, 0x3fb8aa00, v40
    v_rndne_f32 v51, v50
    v_sub_f32 v50, v50, v51
    v_fmamk_f32 v50, v40, 0x36eca570, v50
    v_exp_f32 v50, v50
    v_cvt_i32_f32 v51, v51
    v_ldexp_f32 v43, v50, v51
    v_mul_f32 v52, 0x3fb8aa00, v41
    v_rndne_f32 v53, v52
    v_sub_f32 v52, v52, v53
    v_fmamk_f32 v52, v41, 0x36eca570, v52
    v_exp_f32 v52, v52
    v_cvt_i32_f32 v53, v53
    v_ldexp_f32 v44, v52, v53
    v_mul_f32 v54, 0x3fb8aa00, v42
    v_rndne_f32 v55, v54
    v_sub_f32 v54, v54, v55
    v_fmamk_f32 v54, v42, 0x36eca570, v54
    v_exp_f32 v54, v54
    v_cvt_i32_f32 v55, v55
    v_ldexp_f32 v45, v54, v55
    v_cvt_pk_bf16_f32 v43, v43, v44
    v_cvt_pk_bf16_f32 v45, v45, v45
    v_lshlrev_b32 v45, 16, v45
    v_and_b32 v44, 0xffff0000, v43
    v_lshlrev_b32 v43, 16, v43
    s_waitcnt vmcnt(0)
    v_and_b32 v47, 0xffff0000, v13
    v_lshlrev_b32 v46, 16, v13
    v_mul_f32 v20, -v43, v45
    v_mul_f32 v21, v46, v45
    v_mul_f32 v22, -v44, v45
    v_mul_f32 v23, v47, v45
    v_and_b32 v26, 0xffff0000, v14
    v_lshlrev_b32 v24, 16, v14
    v_and_b32 v27, 0xffff0000, v15
    v_lshlrev_b32 v25, 16, v15
    v_mul_f32 v24, v24, v45
    v_mul_f32 v25, v25, v45
    v_mul_f32 v26, v26, v45
    v_mul_f32 v27, v27, v45
    v_add_f32 v48, abs(v24), abs(v25)
    v_add_f32 v49, abs(v26), abs(v27)
    v_add_f32 v48, v48, v49
    s_nop 1
    v_add_f32_dpp v48, v48, v48 quad_perm:[1,0,3,2] row_mask:0xf bank_mask:0xf
    s_nop 1
    v_add_f32_dpp v48, v48, v48 quad_perm:[2,3,0,1] row_mask:0xf bank_mask:0xf
    s_nop 1
    v_add_f32_dpp v48, v48, v48 row_half_mirror row_mask:0xf bank_mask:0xf
    s_nop 1
    v_add_f32_dpp v48, v48, v48 row_mirror row_mask:0xf bank_mask:0xf
    s_nop 1
    v_add_f32_dpp v48, v48, v48 row_bcast:15 row_mask:0xa bank_mask:0xf
    s_nop 1
    v_add_f32_dpp v48, v48, v48 row_bcast:31 row_mask:0xc bank_mask:0xf
    s_nop 0
    v_readlane_b32 s11, v48, 63
    s_nop 1
    s_max_u32 s11, s11, 0x0d800000
    s_min_u32 s11, s11, 0x71800000
    s_add_u32 s11, s11, 0x00ffffff
    s_and_b32 s11, s11, 0x7f800000
    s_sub_u32 s12, 0x7f800000, s11
    v_mul_f32 v24, s12, v24
    v_mul_f32 v25, s12, v25
    v_mul_f32 v26, s12, v26
    v_mul_f32 v27, s12, v27
    s_lshl_b32 s13, s8, 2
    s_add_u32 s13, s13, 78984
    v_mov_b32 v58, s13
    v_mov_b32 v59, s11
    ds_write_b32 v58, v59
    s_barrier
    s_cmp_eq_u32 s9, 1
    s_cbranch_scc1 KA_R1
    s_cmp_eq_u32 s9, 2
    s_cbranch_scc1 KA_R2
    s_cmp_eq_u32 s9, 3
    s_cbranch_scc1 KA_R3
    v_mul_f32 v50, 0x4138aa3b, v20
    v_mul_f32 v51, 0x3fa30000, v21
    v_exp_f32 v50, v50
    v_fract_f32 v51, v51
    v_fmamk_f32 v51, v21, 0xb94f9236, v51
    v_cos_f32 v70, v51
    v_sin_f32 v71, v51
    v_mul_f32 v70, v50, v70
    v_mul_f32 v71, v50, v71
    v_mul_f32 v52, 0x4138aa3b, v22
    v_mul_f32 v53, 0x3fa30000, v23
    v_exp_f32 v52, v52
    v_fract_f32 v53, v53
    v_fmamk_f32 v53, v23, 0xb94f9236, v53
    v_cos_f32 v72, v53
    v_sin_f32 v73, v53
    v_mul_f32 v72, v52, v72
    v_mul_f32 v73, v52, v73
    v_mov_b32 v60, 0x00003c00
    v_mov_b32 v61, 0x00003c00
    ds_write_b64 v6, v[60:61] offset:22304
    v_cvt_pk_f16_f32 v62, v70, v71
    v_cvt_pk_f16_f32 v63, v72, v73
    ds_write_b64 v6, v[62:63] offset:22848
    v_pk_mul_f32 v[74:75], v[70:71], v[70:71] op_sel:[0,0] op_sel_hi:[0,1]
    v_pk_fma_f32 v[74:75], v[70:71], v[70:71], v[74:75] op_sel:[1,1,0] op_sel_hi:[1,0,1] neg_lo:[0,1,0]
    v_pk_mul_f32 v[76:77], v[72:73], v[72:73] op_sel:[0,0] op_sel_hi:[0,1]
    v_pk_fma_f32 v[76:77], v[72:73], v[72:73], v[76:77] op_sel:[1,1,0] op_sel_hi:[1,0,1] neg_lo:[0,1,0]
    v_cvt_pk_f16_f32 v60, v74, v75
    v_cvt_pk_f16_f32 v61, v76, v77
    ds_write_b64 v6, v[60:61] offset:23392
    v_pk_mul_f32 v[78:79], v[74:75], v[70:71] op_sel:[0,0] op_sel_hi:[0,1]
    v_pk_fma_f32 v[78:79], v[74:75], v[70:71], v[78:79] op_sel:[1,1,0] op_sel_hi:[1,0,1] neg_lo:[0,1,0]
    v_pk_mul_f32 v[80:81], v[76:77], v[72:73] op_sel:[0,0] op_sel_hi:[0,1]
    v_pk_fma_f32 v[80:81], v[76:77], v[72:73], v[80:81] op_sel:[1,1,0] op_sel_hi:[1,0,1] neg_lo:[0,1,0]
    v_cvt_pk_f16_f32 v62, v78, v79
    v_cvt_pk_f16_f32 v63, v80, v81
    ds_write_b64 v6, v[62:63] offset:23936
    v_pk_mul_f32 v[74:75], v[78:79], v[70:71] op_sel:[0,0] op_sel_hi:[0,1]
    v_pk_fma_f32 v[74:75], v[78:79], v[70:71], v[74:75] op_sel:[1,1,0] op_sel_hi:[1,0,1] neg_lo:[0,1,0]
    v_pk_mul_f32 v[76:77], v[80:81], v[72:73] op_sel:[0,0] op_sel_hi:[0,1]
    v_pk_fma_f32 v[76:77], v[80:81], v[72:73], v[76:77] op_sel:[1,1,0] op_sel_hi:[1,0,1] neg_lo:[0,1,0]
    v_cvt_pk_f16_f32 v60, v74, v75
    v_cvt_pk_f16_f32 v61, v76, v77
    ds_write_b64 v6, v[60:61] offset:24480
    v_pk_mul_f32 v[78:79], v[74:75], v[70:71] op_sel:[0,0] op_sel_hi:[0,1]
    v_pk_fma_f32 v[78:79], v[74:75], v[70:71], v[78:79] op_sel:[1,1,0] op_sel_hi:[1,0,1] neg_lo:[0,1,0]
    v_pk_mul_f32 v[80:81], v[76:77], v[72:73] op_sel:[0,0] op_sel_hi:[0,1]
    v_pk_fma_f32 v[80:81], v[76:77], v[72:73], v[80:81] op_sel:[1,1,0] op_sel_hi:[1,0,1] neg_lo:[0,1,0]
    v_cvt_pk_f16_f32 v62, v78, v79
    v_cvt_pk_f16_f32 v63, v80, v81
    ds_write_b64 v6, v[62:63] offset:25024
    v_pk_mul_f32 v[74:75], v[78:79], v[70:71] op_sel:[0,0] op_sel_hi:[0,1]
    v_pk_fma_f32 v[74:75], v[78:79], v[70:71], v[74:75] op_sel:[1,1,0] op_sel_hi:[1,0,1] neg_lo:[0,1,0]
    v_pk_mul_f32 v[76:77], v[80:81], v[72:73] op_sel:[0,0] op_sel_hi:[0,1]
    v_pk_fma_f32 v[76:77], v[80:81], v[72:73], v[76:77] op_sel:[1,1,0] op_sel_hi:[1,0,1] neg_lo:[0,1,0]
    v_cvt_pk_f16_f32 v60, v74, v75
    v_cvt_pk_f16_f32 v61, v76, v77
    ds_write_b64 v6, v[60:61] offset:25568
    v_pk_mul_f32 v[78:79], v[74:75], v[70:71] op_sel:[0,0] op_sel_hi:[0,1]
    v_pk_fma_f32 v[78:79], v[74:75], v[70:71], v[78:79] op_sel:[1,1,0] op_sel_hi:[1,0,1] neg_lo:[0,1,0]
    v_pk_mul_f32 v[80:81], v[76:77], v[72:73] op_sel:[0,0] op_sel_hi:[0,1]
    v_pk_fma_f32 v[80:81], v[76:77], v[72:73], v[80:81] op_sel:[1,1,0] op_sel_hi:[1,0,1] neg_lo:[0,1,0]
    v_cvt_pk_f16_f32 v62, v78, v79
    v_cvt_pk_f16_f32 v63, v80, v81
    ds_write_b64 v6, v[62:63] offset:26112
    v_pk_mul_f32 v[74:75], v[78:79], v[70:71] op_sel:[0,0] op_sel_hi:[0,1]
    v_pk_fma_f32 v[74:75], v[78:79], v[70:71], v[74:75] op_sel:[1,1,0] op_sel_hi:[1,0,1] neg_lo:[0,1,0]
    v_pk_mul_f32 v[76:77], v[80:81], v[72:73] op_sel:[0,0] op_sel_hi:[0,1]
    v_pk_fma_f32 v[76:77], v[80:81], v[72:73], v[76:77] op_sel:[1,1,0] op_sel_hi:[1,0,1] neg_lo:[0,1,0]
    v_cvt_pk_f16_f32 v60, v74, v75
    v_cvt_pk_f16_f32 v61, v76, v77
    ds_write_b64 v6, v[60:61] offset:26656
    v_pk_mul_f32 v[78:79], v[74:75], v[70:71] op_sel:[0,0] op_sel_hi:[0,1]
    v_pk_fma_f32 v[78:79], v[74:75], v[70:71], v[78:79] op_sel:[1,1,0] op_sel_hi:[1,0,1] neg_lo:[0,1,0]
    v_pk_mul_f32 v[80:81], v[76:77], v[72:73] op_sel:[0,0] op_sel_hi:[0,1]
    v_pk_fma_f32 v[80:81], v[76:77], v[72:73], v[80:81] op_sel:[1,1,0] op_sel_hi:[1,0,1] neg_lo:[0,1,0]
    v_cvt_pk_f16_f32 v62, v78, v79
    v_cvt_pk_f16_f32 v63, v80, v81
    ds_write_b64 v6, v[62:63] offset:27200
    v_pk_mul_f32 v[74:75], v[78:79], v[70:71] op_sel:[0,0] op_sel_hi:[0,1]
    v_pk_fma_f32 v[74:75], v[78:79], v[70:71], v[74:75] op_sel:[1,1,0] op_sel_hi:[1,0,1] neg_lo:[0,1,0]
    v_pk_mul_f32 v[76:77], v[80:81], v[72:73] op_sel:[0,0] op_sel_hi:[0,1]
    v_pk_fma_f32 v[76:77], v[80:81], v[72:73], v[76:77] op_sel:[1,1,0] op_sel_hi:[1,0,1] neg_lo:[0,1,0]
    v_cvt_pk_f16_f32 v60, v74, v75
    v_cvt_pk_f16_f32 v61, v76, v77
    ds_write_b64 v6, v[60:61] offset:27744
    v_pk_mul_f32 v[78:79], v[74:75], v[70:71] op_sel:[0,0] op_sel_hi:[0,1]
    v_pk_fma_f32 v[78:79], v[74:75], v[70:71], v[78:79] op_sel:[1,1,0] op_sel_hi:[1,0,1] neg_lo:[0,1,0]
    v_pk_mul_f32 v[80:81], v[76:77], v[72:73] op_sel:[0,0] op_sel_hi:[0,1]
    v_pk_fma_f32 v[80:81], v[76:77], v[72:73], v[80:81] op_sel:[1,1,0] op_sel_hi:[1,0,1] neg_lo:[0,1,0]
    v_cvt_pk_f16_f32 v62, v78, v79
    v_cvt_pk_f16_f32 v63, v80, v81
    ds_write_b64 v6, v[62:63] offset:28288
    v_pk_mul_f32 v[74:75], v[78:79], v[70:71] op_sel:[0,0] op_sel_hi:[0,1]
    v_pk_fma_f32 v[74:75], v[78:79], v[70:71], v[74:75] op_sel:[1,1,0] op_sel_hi:[1,0,1] neg_lo:[0,1,0]
    v_pk_mul_f32 v[76:77], v[80:81], v[72:73] op_sel:[0,0] op_sel_hi:[0,1]
    v_pk_fma_f32 v[76:77], v[80:81], v[72:73], v[76:77] op_sel:[1,1,0] op_sel_hi:[1,0,1] neg_lo:[0,1,0]
    v_cvt_pk_f16_f32 v60, v74, v75
    v_cvt_pk_f16_f32 v61, v76, v77
    ds_write_b64 v6, v[60:61] offset:28832
    v_pk_mul_f32 v[78:79], v[74:75], v[70:71] op_sel:[0,0] op_sel_hi:[0,1]
    v_pk_fma_f32 v[78:79], v[74:75], v[70:71], v[78:79] op_sel:[1,1,0] op_sel_hi:[1,0,1] neg_lo:[0,1,0]
    v_pk_mul_f32 v[80:81], v[76:77], v[72:73] op_sel:[0,0] op_sel_hi:[0,1]
    v_pk_fma_f32 v[80:81], v[76:77], v[72:73], v[80:81] op_sel:[1,1,0] op_sel_hi:[1,0,1] neg_lo:[0,1,0]
    v_cvt_pk_f16_f32 v62, v78, v79
    v_cvt_pk_f16_f32 v63, v80, v81
    ds_write_b64 v6, v[62:63] offset:29376
    v_pk_mul_f32 v[74:75], v[78:79], v[70:71] op_sel:[0,0] op_sel_hi:[0,1]
    v_pk_fma_f32 v[74:75], v[78:79], v[70:71], v[74:75] op_sel:[1,1,0] op_sel_hi:[1,0,1] neg_lo:[0,1,0]
    v_pk_mul_f32 v[76:77], v[80:81], v[72:73] op_sel:[0,0] op_sel_hi:[0,1]
    v_pk_fma_f32 v[76:77], v[80:81], v[72:73], v[76:77] op_sel:[1,1,0] op_sel_hi:[1,0,1] neg_lo:[0,1,0]
    v_cvt_pk_f16_f32 v60, v74, v75
    v_cvt_pk_f16_f32 v61, v76, v77
    ds_write_b64 v6, v[60:61] offset:29920
    v_pk_mul_f32 v[78:79], v[74:75], v[70:71] op_sel:[0,0] op_sel_hi:[0,1]
    v_pk_fma_f32 v[78:79], v[74:75], v[70:71], v[78:79] op_sel:[1,1,0] op_sel_hi:[1,0,1] neg_lo:[0,1,0]
    v_pk_mul_f32 v[80:81], v[76:77], v[72:73] op_sel:[0,0] op_sel_hi:[0,1]
    v_pk_fma_f32 v[80:81], v[76:77], v[72:73], v[80:81] op_sel:[1,1,0] op_sel_hi:[1,0,1] neg_lo:[0,1,0]
    v_cvt_pk_f16_f32 v62, v78, v79
    v_cvt_pk_f16_f32 v63, v80, v81
    ds_write_b64 v6, v[62:63] offset:30464
    s_nop 1
    s_branch KA_RDONE
KA_R1:
    v_mul_f32 v50, 0x3fb8aa3b, v20
    v_mul_f32 v51, 0x3e230000, v21
    v_exp_f32 v50, v50
    v_fract_f32 v51, v51
    v_fmamk_f32 v51, v21, 0xb7cf9236, v51
    v_cos_f32 v70, v51
    v_sin_f32 v71, v51
    v_mul_f32 v70, v50, v70
    v_mul_f32 v71, v50, v71
    v_mul_f32 v52, 0x3fb8aa3b, v22
    v_mul_f32 v53, 0x3e230000, v23
    v_exp_f32 v52, v52
    v_fract_f32 v53, v53
    v_fmamk_f32 v53, v23, 0xb7cf9236, v53
    v_cos_f32 v72, v53
    v_sin_f32 v73, v53
    v_mul_f32 v72, v52, v72
    v_mul_f32 v73, v52, v73
    v_mul_f32 v54, 0x4338aa3b, v20
    v_mul_f32 v55, 0x41a30000, v21
    v_exp_f32 v54, v54
    v_fract_f32 v55, v55
    v_fmamk_f32 v55, v21, 0xbb4f9236, v55
    v_cos_f32 v82, v55
    v_sin_f32 v83, v55
    v_mul_f32 v82, v54, v82
    v_mul_f32 v83, v54, v83
    v_mul_f32 v56, 0x4338aa3b, v22
    v_mul_f32 v57, 0x41a30000, v23
    v_exp_f32 v56, v56
    v_fract_f32 v57, v57
    v_fmamk_f32 v57, v23, 0xbb4f9236, v57
    v_cos_f32 v84, v57
    v_sin_f32 v85, v57
    v_mul_f32 v84, v56, v84
    v_mul_f32 v85, v56, v85
    v_cvt_pk_f16_f32 v60, v24, -v25
    v_cvt_pk_f16_f32 v61, v26, -v27
    ds_write_b64 v6, v[60:61] offset:0
    v_pk_mul_f32 v[74:75], v[24:25], v[70:71] op_sel:[0,0] op_sel_hi:[0,1]
    v_pk_fma_f32 v[74:75], v[24:25], v[70:71], v[74:75] op_sel:[1,1,0] op_sel_hi:[1,0,1] neg_lo:[0,1,0]
    v_pk_mul_f32 v[76:77], v[26:27], v[72:73] op_sel:[0,0] op_sel_hi:[0,1]
    v_pk_fma_f32 v[76:77], v[26:27], v[72:73], v[76:77] op_sel:[1,1,0] op_sel_hi:[1,0,1] neg_lo:[0,1,0]
    v_cvt_pk_f16_f32 v62, v74, -v75
    v_cvt_pk_f16_f32 v63, v76, -v77
    ds_write_b64 v6, v[62:63] offset:544
    v_pk_mul_f32 v[78:79], v[74:75], v[70:71] op_sel:[0,0] op_sel_hi:[0,1]
    v_pk_fma_f32 v[78:79], v[74:75], v[70:71], v[78:79] op_sel:[1,1,0] op_sel_hi:[1,0,1] neg_lo:[0,1,0]
    v_pk_mul_f32 v[80:81], v[76:77], v[72:73] op_sel:[0,0] op_sel_hi:[0,1]
    v_pk_fma_f32 v[80:81], v[76:77], v[72:73], v[80:81] op_sel:[1,1,0] op_sel_hi:[1,0,1] neg_lo:[0,1,0]
    v_cvt_pk_f16_f32 v60, v78, -v79
    v_cvt_pk_f16_f32 v61, v80, -v81
    ds_write_b64 v6, v[60:61] offset:1088
    v_pk_mul_f32 v[74:75], v[78:79], v[70:71] op_sel:[0,0] op_sel_hi:[0,1]
    v_pk_fma_f32 v[74:75], v[78:79], v[70:71], v[74:75] op_sel:[1,1,0] op_sel_hi:[1,0,1] neg_lo:[0,1,0]
    v_pk_mul_f32 v[76:77], v[80:81], v[72:73] op_sel:[0,0] op_sel_hi:[0,1]
    v_pk_fma_f32 v[76:77], v[80:81], v[72:73], v[76:77] op_sel:[1,1,0] op_sel_hi:[1,0,1] neg_lo:[0,1,0]
    v_cvt_pk_f16_f32 v62, v74, -v75
    v_cvt_pk_f16_f32 v63, v76, -v77
    ds_write_b64 v6, v[62:63] offset:1632
    v_pk_mul_f32 v[78:79], v[74:75], v[70:71] op_sel:[0,0] op_sel_hi:[0,1]
    v_pk_fma_f32 v[78:79], v[74:75], v[70:71], v[78:79] op_sel:[1,1,0] op_sel_hi:[1,0,1] neg_lo:[0,1,0]
    v_pk_mul_f32 v[80:81], v[76:77], v[72:73] op_sel:[0,0] op_sel_hi:[0,1]
    v_pk_fma_f32 v[80:81], v[76:77], v[72:73], v[80:81] op_sel:[1,1,0] op_sel_hi:[1,0,1] neg_lo:[0,1,0]
    v_cvt_pk_f16_f32 v60, v78, -v79
    v_cvt_pk_f16_f32 v61, v80, -v81
    ds_write_b64 v6, v[60:61] offset:2176
    v_pk_mul_f32 v[74:75], v[78:79], v[70:71] op_sel:[0,0] op_sel_hi:[0,1]
    v_pk_fma_f32 v[74:75], v[78:79], v[70:71], v[74:75] op_sel:[1,1,0] op_sel_hi:[1,0,1] neg_lo:[0,1,0]
    v_pk_mul_f32 v[76:77], v[80:81], v[72:73] op_sel:[0,0] op_sel_hi:[0,1]
    v_pk_fma_f32 v[76:77], v[80:81], v[72:73], v[76:77] op_sel:[1,1,0] op_sel_hi:[1,0,1] neg_lo:[0,1,0]
    v_cvt_pk_f16_f32 v62, v74, -v75
    v_cvt_pk_f16_f32 v63, v76, -v77
    ds_write_b64 v6, v[62:63] offset:2720
    v_pk_mul_f32 v[78:79], v[74:75], v[70:71] op_sel:[0,0] op_sel_hi:[0,1]
    v_pk_fma_f32 v[78:79], v[74:75], v[70:71], v[78:79] op_sel:[1,1,0] op_sel_hi:[1,0,1] neg_lo:[0,1,0]
    v_pk_mul_f32 v[80:81], v[76:77], v[72:73] op_sel:[0,0] op_sel_hi:[0,1]
    v_pk_fma_f32 v[80:81], v[76:77], v[72:73], v[80:81] op_sel:[1,1,0] op_sel_hi:[1,0,1] neg_lo:[0,1,0]
    v_cvt_pk_f16_f32 v60, v78, -v79
    v_cvt_pk_f16_f32 v61, v80, -v81
    ds_write_b64 v6, v[60:61] offset:3264
    v_pk_mul_f32 v[74:75], v[78:79], v[70:71] op_sel:[0,0] op_sel_hi:[0,1]
    v_pk_fma_f32 v[74:75], v[78:79], v[70:71], v[74:75] op_sel:[1,1,0] op_sel_hi:[1,0,1] neg_lo:[0,1,0]
    v_pk_mul_f32 v[76:77], v[80:81], v[72:73] op_sel:[0,0] op_sel_hi:[0,1]
    v_pk_fma_f32 v[76:77], v[80:81], v[72:73], v[76:77] op_sel:[1,1,0] op_sel_hi:[1,0,1] neg_lo:[0,1,0]
    v_cvt_pk_f16_f32 v62, v74, -v75
    v_cvt_pk_f16_f32 v63, v76, -v77
    ds_write_b64 v6, v[62:63] offset:3808
    v_pk_mul_f32 v[78:79], v[24:25], v[82:83] op_sel:[0,0] op_sel_hi:[0,1]
    v_pk_fma_f32 v[78:79], v[24:25], v[82:83], v[78:79] op_sel:[1,1,0] op_sel_hi:[1,0,1] neg_lo:[0,1,0]
    v_pk_mul_f32 v[80:81], v[26:27], v[84:85] op_sel:[0,0] op_sel_hi:[0,1]
    v_pk_fma_f32 v[80:81], v[26:27], v[84:85], v[80:81] op_sel:[1,1,0] op_sel_hi:[1,0,1] neg_lo:[0,1,0]
    v_cvt_pk_f16_f32 v60, v78, -v79
    v_cvt_pk_f16_f32 v61, v80, -v81
    ds_write_b64 v6, v[60:61] offset:4352
    v_pk_mul_f32 v[74:75], v[78:79], v[70:71] op_sel:[0,0] op_sel_hi:[0,1]
    v_pk_fma_f32 v[74:75], v[78:79], v[70:71], v[74:75] op_sel:[1,1,0] op_sel_hi:[1,0,1] neg_lo:[0,1,0]
    v_pk_mul_f32 v[76:77], v[80:81], v[72:73] op_sel:[0,0] op_sel_hi:[0,1]
    v_pk_fma_f32 v[76:77], v[80:81], v[72:73], v[76:77] op_sel:[1,1,0] op_sel_hi:[1,0,1] neg_lo:[0,1,0]
    v_cvt_pk_f16_f32 v62, v74, -v75
    v_cvt_pk_f16_f32 v63, v76, -v77
    ds_write_b64 v6, v[62:63] offset:4896
    v_pk_mul_f32 v[78:79], v[74:75], v[70:71] op_sel:[0,0] op_sel_hi:[0,1]
    v_pk_fma_f32 v[78:79], v[74:75], v[70:71], v[78:79] op_sel:[1,1,0] op_sel_hi:[1,0,1] neg_lo:[0,1,0]
    v_pk_mul_f32 v[80:81], v[76:77], v[72:73] op_sel:[0,0] op_sel_hi:[0,1]
    v_pk_fma_f32 v[80:81], v[76:77], v[72:73], v[80:81] op_sel:[1,1,0] op_sel_hi:[1,0,1] neg_lo:[0,1,0]
    v_cvt_pk_f16_f32 v60, v78, -v79
    v_cvt_pk_f16_f32 v61, v80, -v81
    ds_write_b64 v6, v[60:61] offset:5440
    v_pk_mul_f32 v[74:75], v[78:79], v[70:71] op_sel:[0,0] op_sel_hi:[0,1]
    v_pk_fma_f32 v[74:75], v[78:79], v[70:71], v[74:75] op_sel:[1,1,0] op_sel_hi:[1,0,1] neg_lo:[0,1,0]
    v_pk_mul_f32 v[76:77], v[80:81], v[72:73] op_sel:[0,0] op_sel_hi:[0,1]
    v_pk_fma_f32 v[76:77], v[80:81], v[72:73], v[76:77] op_sel:[1,1,0] op_sel_hi:[1,0,1] neg_lo:[0,1,0]
    v_cvt_pk_f16_f32 v62, v74, -v75
    v_cvt_pk_f16_f32 v63, v76, -v77
    ds_write_b64 v6, v[62:63] offset:5984
    v_pk_mul_f32 v[78:79], v[74:75], v[70:71] op_sel:[0,0] op_sel_hi:[0,1]
    v_pk_fma_f32 v[78:79], v[74:75], v[70:71], v[78:79] op_sel:[1,1,0] op_sel_hi:[1,0,1] neg_lo:[0,1,0]
    v_pk_mul_f32 v[80:81], v[76:77], v[72:73] op_sel:[0,0] op_sel_hi:[0,1]
    v_pk_fma_f32 v[80:81], v[76:77], v[72:73], v[80:81] op_sel:[1,1,0] op_sel_hi:[1,0,1] neg_lo:[0,1,0]
    v_cvt_pk_f16_f32 v60, v78, -v79
    v_cvt_pk_f16_f32 v61, v80, -v81
    ds_write_b64 v6, v[60:61] offset:6528
    v_pk_mul_f32 v[74:75], v[78:79], v[70:71] op_sel:[0,0] op_sel_hi:[0,1]
    v_pk_fma_f32 v[74:75], v[78:79], v[70:71], v[74:75] op_sel:[1,1,0] op_sel_hi:[1,0,1] neg_lo:[0,1,0]
    v_pk_mul_f32 v[76:77], v[80:81], v[72:73] op_sel:[0,0] op_sel_hi:[0,1]
    v_pk_fma_f32 v[76:77], v[80:81], v[72:73], v[76:77] op_sel:[1,1,0] op_sel_hi:[1,0,1] neg_lo:[0,1,0]
    v_cvt_pk_f16_f32 v62, v74, -v75
    v_cvt_pk_f16_f32 v63, v76, -v77
    ds_write_b64 v6, v[62:63] offset:7072
    v_pk_mul_f32 v[78:79], v[74:75], v[70:71] op_sel:[0,0] op_sel_hi:[0,1]
    v_pk_fma_f32 v[78:79], v[74:75], v[70:71], v[78:79] op_sel:[1,1,0] op_sel_hi:[1,0,1] neg_lo:[0,1,0]
    v_pk_mul_f32 v[80:81], v[76:77], v[72:73] op_sel:[0,0] op_sel_hi:[0,1]
    v_pk_fma_f32 v[80:81], v[76:77], v[72:73], v[80:81] op_sel:[1,1,0] op_sel_hi:[1,0,1] neg_lo:[0,1,0]
    v_cvt_pk_f16_f32 v60, v78, -v79
    v_cvt_pk_f16_f32 v61, v80, -v81
    ds_write_b64 v6, v[60:61] offset:7616
    v_pk_mul_f32 v[74:75], v[78:79], v[70:71] op_sel:[0,0] op_sel_hi:[0,1]
    v_pk_fma_f32 v[74:75], v[78:79], v[70:71], v[74:75] op_sel:[1,1,0] op_sel_hi:[1,0,1] neg_lo:[0,1,0]
    v_pk_mul_f32 v[76:77], v[80:81], v[72:73] op_sel:[0,0] op_sel_hi:[0,1]
    v_pk_fma_f32 v[76:77], v[80:81], v[72:73], v[76:77] op_sel:[1,1,0] op_sel_hi:[1,0,1] neg_lo:[0,1,0]
    v_cvt_pk_f16_f32 v62, v74, -v75
    v_cvt_pk_f16_f32 v63, v76, -v77
    ds_write_b64 v6, v[62:63] offset:8160
    s_nop 1
    s_branch KA_RDONE
KA_R2:
    v_mul_f32 v50, 0x4038aa3b, v20
    v_mul_f32 v51, 0x3ea30000, v21
    v_exp_f32 v50, v50
    v_fract_f32 v51, v51
    v_fmamk_f32 v51, v21, 0xb84f9236, v51
    v_cos_f32 v70, v51
    v_sin_f32 v71, v51
    v_mul_f32 v70, v50, v70
    v_mul_f32 v71, v50, v71
    v_mul_f32 v52, 0x4038aa3b, v22
    v_mul_f32 v53, 0x3ea30000, v23
    v_exp_f32 v52, v52
    v_fract_f32 v53, v53
    v_fmamk_f32 v53, v23, 0xb84f9236, v53
    v_cos_f32 v72, v53
    v_sin_f32 v73, v53
    v_mul_f32 v72, v52, v72
    v_mul_f32 v73, v52, v73
    v_mul_f32 v54, 0x4338aa3b, v20
    v_mul_f32 v55, 0x41a30000, v21
    v_exp_f32 v54, v54
    v_fract_f32 v55, v55
    v_fmamk_f32 v55, v21, 0xbb4f9236, v55
    v_cos_f32 v82, v55
    v_sin_f32 v83, v55
    v_mul_f32 v82, v54, v82
    v_mul_f32 v83, v54, v83
    v_mul_f32 v56, 0x4338aa3b, v22
    v_mul_f32 v57, 0x41a30000, v23
    v_exp_f32 v56, v56
    v_fract_f32 v57, v57
    v_fmamk_f32 v57, v23, 0xbb4f9236, v57
    v_cos_f32 v84, v57
    v_sin_f32 v85, v57
    v_mul_f32 v84, v56, v84
    v_mul_f32 v85, v56, v85
    v_mul_f32 v50, 0x43b8aa3b, v20
    v_mul_f32 v51, 0x42230000, v21
    v_exp_f32 v50, v50
    v_fract_f32 v51, v51
    v_fmamk_f32 v51, v21, 0xbbcf9236, v51
    v_cos_f32 v86, v51
    v_sin_f32 v87, v51
    v_mul_f32 v86, v50, v86
    v_mul_f32 v87, v50, v87
    v_mul_f32 v52, 0x43b8aa3b, v22
    v_mul_f32 v53, 0x42230000, v23
    v_exp_f32 v52, v52
    v_fract_f32 v53, v53
    v_fmamk_f32 v53, v23, 0xbbcf9236, v53
    v_cos_f32 v88, v53
    v_sin_f32 v89, v53
    v_mul_f32 v88, v52, v88
    v_mul_f32 v89, v52, v89
    v_pk_mul_f32 v[90:91], v[70:71], v[70:71] op_sel:[0,0] op_sel_hi:[0,1]
    v_pk_fma_f32 v[90:91], v[70:71], v[70:71], v[90:91] op_sel:[1,1,0] op_sel_hi:[1,0,1] neg_lo:[0,1,0]
    v_pk_mul_f32 v[92:93], v[72:73], v[72:73] op_sel:[0,0] op_sel_hi:[0,1]
    v_pk_fma_f32 v[92:93], v[72:73], v[72:73], v[92:93] op_sel:[1,1,0] op_sel_hi:[1,0,1] neg_lo:[0,1,0]
    v_pk_mul_f32 v[94:95], v[24:25], v[86:87] op_sel:[0,0] op_sel_hi:[0,1]
    v_pk_fma_f32 v[94:95], v[24:25], v[86:87], v[94:95] op_sel:[1,1,0] op_sel_hi:[1,0,1] neg_lo:[0,1,0]
    v_pk_mul_f32 v[96:97], v[26:27], v[88:89] op_sel:[0,0] op_sel_hi:[0,1]
    v_pk_fma_f32 v[96:97], v[26:27], v[88:89], v[96:97] op_sel:[1,1,0] op_sel_hi:[1,0,1] neg_lo:[0,1,0]
    v_cvt_pk_f16_f32 v60, v94, -v95
    v_cvt_pk_f16_f32 v61, v96, -v97
    ds_write_b64 v6, v[60:61] offset:8704
    v_pk_mul_f32 v[74:75], v[94:95], v[70:71] op_sel:[0,0] op_sel_hi:[0,1]
    v_pk_fma_f32 v[74:75], v[94:95], v[70:71], v[74:75] op_sel:[1,1,0] op_sel_hi:[1,0,1] neg_lo:[0,1,0]
    v_pk_mul_f32 v[76:77], v[96:97], v[72:73] op_sel:[0,0] op_sel_hi:[0,1]
    v_pk_fma_f32 v[76:77], v[96:97], v[72:73], v[76:77] op_sel:[1,1,0] op_sel_hi:[1,0,1] neg_lo:[0,1,0]
    v_cvt_pk_f16_f32 v62, v74, -v75
    v_cvt_pk_f16_f32 v63, v76, -v77
    ds_write_b64 v6, v[62:63] offset:9248
    v_pk_mul_f32 v[78:79], v[74:75], v[70:71] op_sel:[0,0] op_sel_hi:[0,1]
    v_pk_fma_f32 v[78:79], v[74:75], v[70:71], v[78:79] op_sel:[1,1,0] op_sel_hi:[1,0,1] neg_lo:[0,1,0]
    v_pk_mul_f32 v[80:81], v[76:77], v[72:73] op_sel:[0,0] op_sel_hi:[0,1]
    v_pk_fma_f32 v[80:81], v[76:77], v[72:73], v[80:81] op_sel:[1,1,0] op_sel_hi:[1,0,1] neg_lo:[0,1,0]
    v_cvt_pk_f16_f32 v60, v78, -v79
    v_cvt_pk_f16_f32 v61, v80, -v81
    ds_write_b64 v6, v[60:61] offset:9792
    v_pk_mul_f32 v[74:75], v[78:79], v[70:71] op_sel:[0,0] op_sel_hi:[0,1]
    v_pk_fma_f32 v[74:75], v[78:79], v[70:71], v[74:75] op_sel:[1,1,0] op_sel_hi:[1,0,1] neg_lo:[0,1,0]
    v_pk_mul_f32 v[76:77], v[80:81], v[72:73] op_sel:[0,0] op_sel_hi:[0,1]
    v_pk_fma_f32 v[76:77], v[80:81], v[72:73], v[76:77] op_sel:[1,1,0] op_sel_hi:[1,0,1] neg_lo:[0,1,0]
    v_cvt_pk_f16_f32 v62, v74, -v75
    v_cvt_pk_f16_f32 v63, v76, -v77
    ds_write_b64 v6, v[62:63] offset:10336
    v_pk_mul_f32 v[98:99], v[94:95], v[82:83] op_sel:[0,0] op_sel_hi:[0,1]
    v_pk_fma_f32 v[98:99], v[94:95], v[82:83], v[98:99] op_sel:[1,1,0] op_sel_hi:[1,0,1] neg_lo:[0,1,0]
    v_pk_mul_f32 v[100:101], v[96:97], v[84:85] op_sel:[0,0] op_sel_hi:[0,1]
    v_pk_fma_f32 v[100:101], v[96:97], v[84:85], v[100:101] op_sel:[1,1,0] op_sel_hi:[1,0,1] neg_lo:[0,1,0]
    v_cvt_pk_f16_f32 v60, v98, -v99
    v_cvt_pk_f16_f32 v61, v100, -v101
    ds_write_b64 v6, v[60:61] offset:10880
    v_pk_mul_f32 v[74:75], v[98:99], v[70:71] op_sel:[0,0] op_sel_hi:[0,1]
    v_pk_fma_f32 v[74:75], v[98:99], v[70:71], v[74:75] op_sel:[1,1,0] op_sel_hi:[1,0,1] neg_lo:[0,1,0]
    v_pk_mul_f32 v[76:77], v[100:101], v[72:73] op_sel:[0,0] op_sel_hi:[0,1]
    v_pk_fma_f32 v[76:77], v[100:101], v[72:73], v[76:77] op_sel:[1,1,0] op_sel_hi:[1,0,1] neg_lo:[0,1,0]
    v_cvt_pk_f16_f32 v62, v74, -v75
    v_cvt_pk_f16_f32 v63, v76, -v77
    ds_write_b64 v6, v[62:63] offset:11424
    v_pk_mul_f32 v[78:79], v[74:75], v[70:71] op_sel:[0,0] op_sel_hi:[0,1]
    v_pk_fma_f32 v[78:79], v[74:75], v[70:71], v[78:79] op_sel:[1,1,0] op_sel_hi:[1,0,1] neg_lo:[0,1,0]
    v_pk_mul_f32 v[80:81], v[76:77], v[72:73] op_sel:[0,0] op_sel_hi:[0,1]
    v_pk_fma_f32 v[80:81], v[76:77], v[72:73], v[80:81] op_sel:[1,1,0] op_sel_hi:[1,0,1] neg_lo:[0,1,0]
    v_cvt_pk_f16_f32 v60, v78, -v79
    v_cvt_pk_f16_f32 v61, v80, -v81
    ds_write_b64 v6, v[60:61] offset:11968
    v_pk_mul_f32 v[74:75], v[78:79], v[70:71] op_sel:[0,0] op_sel_hi:[0,1]
    v_pk_fma_f32 v[74:75], v[78:79], v[70:71], v[74:75] op_sel:[1,1,0] op_sel_hi:[1,0,1] neg_lo:[0,1,0]
    v_pk_mul_f32 v[76:77], v[80:81], v[72:73] op_sel:[0,0] op_sel_hi:[0,1]
    v_pk_fma_f32 v[76:77], v[80:81], v[72:73], v[76:77] op_sel:[1,1,0] op_sel_hi:[1,0,1] neg_lo:[0,1,0]
    v_cvt_pk_f16_f32 v62, v74, -v75
    v_cvt_pk_f16_f32 v63, v76, -v77
    ds_write_b64 v6, v[62:63] offset:12512
    v_pk_mul_f32 v[94:95], v[98:99], v[82:83] op_sel:[0,0] op_sel_hi:[0,1]
    v_pk_fma_f32 v[94:95], v[98:99], v[82:83], v[94:95] op_sel:[1,1,0] op_sel_hi:[1,0,1] neg_lo:[0,1,0]
    v_pk_mul_f32 v[96:97], v[100:101], v[84:85] op_sel:[0,0] op_sel_hi:[0,1]
    v_pk_fma_f32 v[96:97], v[100:101], v[84:85], v[96:97] op_sel:[1,1,0] op_sel_hi:[1,0,1] neg_lo:[0,1,0]
    v_cvt_pk_f16_f32 v60, v94, -v95
    v_cvt_pk_f16_f32 v61, v96, -v97
    ds_write_b64 v6, v[60:61] offset:13056
    v_pk_mul_f32 v[74:75], v[94:95], v[90:91] op_sel:[0,0] op_sel_hi:[0,1]
    v_pk_fma_f32 v[74:75], v[94:95], v[90:91], v[74:75] op_sel:[1,1,0] op_sel_hi:[1,0,1] neg_lo:[0,1,0]
    v_pk_mul_f32 v[76:77], v[96:97], v[92:93] op_sel:[0,0] op_sel_hi:[0,1]
    v_pk_fma_f32 v[76:77], v[96:97], v[92:93], v[76:77] op_sel:[1,1,0] op_sel_hi:[1,0,1] neg_lo:[0,1,0]
    v_cvt_pk_f16_f32 v62, v74, -v75
    v_cvt_pk_f16_f32 v63, v76, -v77
    ds_write_b64 v6, v[62:63] offset:13600
    v_pk_mul_f32 v[98:99], v[94:95], v[82:83] op_sel:[0,0] op_sel_hi:[0,1]
    v_pk_fma_f32 v[98:99], v[94:95], v[82:83], v[98:99] op_sel:[1,1,0] op_sel_hi:[1,0,1] neg_lo:[0,1,0]
    v_pk_mul_f32 v[100:101], v[96:97], v[84:85] op_sel:[0,0] op_sel_hi:[0,1]
    v_pk_fma_f32 v[100:101], v[96:97], v[84:85], v[100:101] op_sel:[1,1,0] op_sel_hi:[1,0,1] neg_lo:[0,1,0]
    v_cvt_pk_f16_f32 v60, v98, -v99
    v_cvt_pk_f16_f32 v61, v100, -v101
    ds_write_b64 v6, v[60:61] offset:14144
    v_pk_mul_f32 v[78:79], v[98:99], v[90:91] op_sel:[0,0] op_sel_hi:[0,1]
    v_pk_fma_f32 v[78:79], v[98:99], v[90:91], v[78:79] op_sel:[1,1,0] op_sel_hi:[1,0,1] neg_lo:[0,1,0]
    v_pk_mul_f32 v[80:81], v[100:101], v[92:93] op_sel:[0,0] op_sel_hi:[0,1]
    v_pk_fma_f32 v[80:81], v[100:101], v[92:93], v[80:81] op_sel:[1,1,0] op_sel_hi:[1,0,1] neg_lo:[0,1,0]
    v_cvt_pk_f16_f32 v62, v78, -v79
    v_cvt_pk_f16_f32 v63, v80, -v81
    ds_write_b64 v6, v[62:63] offset:14688
    s_nop 1
    s_branch KA_RDONE
KA_R3:
    v_mul_f32 v54, 0x4338aa3b, v20
    v_mul_f32 v55, 0x41a30000, v21
    v_exp_f32 v54, v54
    v_fract_f32 v55, v55
    v_fmamk_f32 v55, v21, 0xbb4f9236, v55
    v_cos_f32 v82, v55
    v_sin_f32 v83, v55
    v_mul_f32 v82, v54, v82
    v_mul_f32 v83, v54, v83
    v_mul_f32 v56, 0x4338aa3b, v22
    v_mul_f32 v57, 0x41a30000, v23
    v_exp_f32 v56, v56
    v_fract_f32 v57, v57
    v_fmamk_f32 v57, v23, 0xbb4f9236, v57
    v_cos_f32 v84, v57
    v_sin_f32 v85, v57
    v_mul_f32 v84, v56, v84
    v_mul_f32 v85, v56, v85
    v_mul_f32 v50, 0x4438aa3b, v20
    v_mul_f32 v51, 0x42a30000, v21
    v_exp_f32 v50, v50
    v_fract_f32 v51, v51
    v_fmamk_f32 v51, v21, 0xbc4f9236, v51
    v_cos_f32 v86, v51
    v_sin_f32 v87, v51
    v_mul_f32 v86, v50, v86
    v_mul_f32 v87, v50, v87
    v_mul_f32 v52, 0x4438aa3b, v22
    v_mul_f32 v53, 0x42a30000, v23
    v_exp_f32 v52, v52
    v_fract_f32 v53, v53
    v_fmamk_f32 v53, v23, 0xbc4f9236, v53
    v_cos_f32 v88, v53
    v_sin_f32 v89, v53
    v_mul_f32 v88, v52, v88
    v_mul_f32 v89, v52, v89
    v_mul_f32 v54, 0x40b8aa3b, v20
    v_mul_f32 v55, 0x3f230000, v21
    v_exp_f32 v54, v54
    v_fract_f32 v55, v55
    v_fmamk_f32 v55, v21, 0xb8cf9236, v55
    v_cos_f32 v90, v55
    v_sin_f32 v91, v55
    v_mul_f32 v90, v54, v90
    v_mul_f32 v91, v54, v91
    v_mul_f32 v56, 0x40b8aa3b, v22
    v_mul_f32 v57, 0x3f230000, v23
    v_exp_f32 v56, v56
    v_fract_f32 v57, v57
    v_fmamk_f32 v57, v23, 0xb8cf9236, v57
    v_cos_f32 v92, v57
    v_sin_f32 v93, v57
    v_mul_f32 v92, v56, v92
    v_mul_f32 v93, v56, v93
    v_pk_mul_f32 v[70:71], v[82:83], v[82:83] op_sel:[0,0] op_sel_hi:[0,1]
    v_pk_fma_f32 v[70:71], v[82:83], v[82:83], v[70:71] op_sel:[1,1,0] op_sel_hi:[1,0,1] neg_lo:[0,1,0]
    v_pk_mul_f32 v[72:73], v[84:85], v[84:85] op_sel:[0,0] op_sel_hi:[0,1]
    v_pk_fma_f32 v[72:73], v[84:85], v[84:85], v[72:73] op_sel:[1,1,0] op_sel_hi:[1,0,1] neg_lo:[0,1,0]
    v_pk_mul_f32 v[94:95], v[24:25], v[86:87] op_sel:[0,0] op_sel_hi:[0,1]
    v_pk_fma_f32 v[94:95], v[24:25], v[86:87], v[94:95] op_sel:[1,1,0] op_sel_hi:[1,0,1] neg_lo:[0,1,0]
    v_pk_mul_f32 v[96:97], v[26:27], v[88:89] op_sel:[0,0] op_sel_hi:[0,1]
    v_pk_fma_f32 v[96:97], v[26:27], v[88:89], v[96:97] op_sel:[1,1,0] op_sel_hi:[1,0,1] neg_lo:[0,1,0]
    v_pk_mul_f32 v[98:99], v[94:95], v[70:71] op_sel:[0,0] op_sel_hi:[0,1]
    v_pk_fma_f32 v[98:99], v[94:95], v[70:71], v[98:99] op_sel:[1,1,0] op_sel_hi:[1,0,1] neg_lo:[0,1,0]
    v_pk_mul_f32 v[100:101], v[96:97], v[72:73] op_sel:[0,0] op_sel_hi:[0,1]
    v_pk_fma_f32 v[100:101], v[96:97], v[72:73], v[100:101] op_sel:[1,1,0] op_sel_hi:[1,0,1] neg_lo:[0,1,0]
    v_cvt_pk_f16_f32 v60, v98, -v99
    v_cvt_pk_f16_f32 v61, v100, -v101
    ds_write_b64 v6, v[60:61] offset:15232
    v_pk_mul_f32 v[74:75], v[98:99], v[90:91] op_sel:[0,0] op_sel_hi:[0,1]
    v_pk_fma_f32 v[74:75], v[98:99], v[90:91], v[74:75] op_sel:[1,1,0] op_sel_hi:[1,0,1] neg_lo:[0,1,0]
    v_pk_mul_f32 v[76:77], v[100:101], v[92:93] op_sel:[0,0] op_sel_hi:[0,1]
    v_pk_fma_f32 v[76:77], v[100:101], v[92:93], v[76:77] op_sel:[1,1,0] op_sel_hi:[1,0,1] neg_lo:[0,1,0]
    v_cvt_pk_f16_f32 v62, v74, -v75
    v_cvt_pk_f16_f32 v63, v76, -v77
    ds_write_b64 v6, v[62:63] offset:15776
    v_pk_mul_f32 v[94:95], v[98:99], v[82:83] op_sel:[0,0] op_sel_hi:[0,1]
    v_pk_fma_f32 v[94:95], v[98:99], v[82:83], v[94:95] op_sel:[1,1,0] op_sel_hi:[1,0,1] neg_lo:[0,1,0]
    v_pk_mul_f32 v[96:97], v[100:101], v[84:85] op_sel:[0,0] op_sel_hi:[0,1]
    v_pk_fma_f32 v[96:97], v[100:101], v[84:85], v[96:97] op_sel:[1,1,0] op_sel_hi:[1,0,1] neg_lo:[0,1,0]
    v_cvt_pk_f16_f32 v60, v94, -v95
    v_cvt_pk_f16_f32 v61, v96, -v97
    ds_write_b64 v6, v[60:61] offset:16320
    v_pk_mul_f32 v[78:79], v[94:95], v[90:91] op_sel:[0,0] op_sel_hi:[0,1]
    v_pk_fma_f32 v[78:79], v[94:95], v[90:91], v[78:79] op_sel:[1,1,0] op_sel_hi:[1,0,1] neg_lo:[0,1,0]
    v_pk_mul_f32 v[80:81], v[96:97], v[92:93] op_sel:[0,0] op_sel_hi:[0,1]
    v_pk_fma_f32 v[80:81], v[96:97], v[92:93], v[80:81] op_sel:[1,1,0] op_sel_hi:[1,0,1] neg_lo:[0,1,0]
    v_cvt_pk_f16_f32 v62, v78, -v79
    v_cvt_pk_f16_f32 v63, v80, -v81
    ds_write_b64 v6, v[62:63] offset:16864
    v_pk_mul_f32 v[98:99], v[94:95], v[82:83] op_sel:[0,0] op_sel_hi:[0,1]
    v_pk_fma_f32 v[98:99], v[94:95], v[82:83], v[98:99] op_sel:[1,1,0] op_sel_hi:[1,0,1] neg_lo:[0,1,0]
    v_pk_mul_f32 v[100:101], v[96:97], v[84:85] op_sel:[0,0] op_sel_hi:[0,1]
    v_pk_fma_f32 v[100:101], v[96:97], v[84:85], v[100:101] op_sel:[1,1,0] op_sel_hi:[1,0,1] neg_lo:[0,1,0]
    v_cvt_pk_f16_f32 v60, v98, -v99
    v_cvt_pk_f16_f32 v61, v100, -v101
    ds_write_b64 v6, v[60:61] offset:17408
    v_pk_mul_f32 v[94:95], v[98:99], v[82:83] op_sel:[0,0] op_sel_hi:[0,1]
    v_pk_fma_f32 v[94:95], v[98:99], v[82:83], v[94:95] op_sel:[1,1,0] op_sel_hi:[1,0,1] neg_lo:[0,1,0]
    v_pk_mul_f32 v[96:97], v[100:101], v[84:85] op_sel:[0,0] op_sel_hi:[0,1]
    v_pk_fma_f32 v[96:97], v[100:101], v[84:85], v[96:97] op_sel:[1,1,0] op_sel_hi:[1,0,1] neg_lo:[0,1,0]
    v_cvt_pk_f16_f32 v62, v94, -v95
    v_cvt_pk_f16_f32 v63, v96, -v97
    ds_write_b64 v6, v[62:63] offset:17952
    v_pk_mul_f32 v[98:99], v[94:95], v[82:83] op_sel:[0,0] op_sel_hi:[0,1]
    v_pk_fma_f32 v[98:99], v[94:95], v[82:83], v[98:99] op_sel:[1,1,0] op_sel_hi:[1,0,1] neg_lo:[0,1,0]
    v_pk_mul_f32 v[100:101], v[96:97], v[84:85] op_sel:[0,0] op_sel_hi:[0,1]
    v_pk_fma_f32 v[100:101], v[96:97], v[84:85], v[100:101] op_sel:[1,1,0] op_sel_hi:[1,0,1] neg_lo:[0,1,0]
    v_cvt_pk_f16_f32 v60, v98, -v99
    v_cvt_pk_f16_f32 v61, v100, -v101
    ds_write_b64 v6, v[60:61] offset:18496
    v_pk_mul_f32 v[94:95], v[98:99], v[82:83] op_sel:[0,0] op_sel_hi:[0,1]
    v_pk_fma_f32 v[94:95], v[98:99], v[82:83], v[94:95] op_sel:[1,1,0] op_sel_hi:[1,0,1] neg_lo:[0,1,0]
    v_pk_mul_f32 v[96:97], v[100:101], v[84:85] op_sel:[0,0] op_sel_hi:[0,1]
    v_pk_fma_f32 v[96:97], v[100:101], v[84:85], v[96:97] op_sel:[1,1,0] op_sel_hi:[1,0,1] neg_lo:[0,1,0]
    v_cvt_pk_f16_f32 v62, v94, -v95
    v_cvt_pk_f16_f32 v63, v96, -v97
    ds_write_b64 v6, v[62:63] offset:19040
    v_pk_mul_f32 v[98:99], v[94:95], v[82:83] op_sel:[0,0] op_sel_hi:[0,1]
    v_pk_fma_f32 v[98:99], v[94:95], v[82:83], v[98:99] op_sel:[1,1,0] op_sel_hi:[1,0,1] neg_lo:[0,1,0]
    v_pk_mul_f32 v[100:101], v[96:97], v[84:85] op_sel:[0,0] op_sel_hi:[0,1]
    v_pk_fma_f32 v[100:101], v[96:97], v[84:85], v[100:101] op_sel:[1,1,0] op_sel_hi:[1,0,1] neg_lo:[0,1,0]
    v_cvt_pk_f16_f32 v60, v98, -v99
    v_cvt_pk_f16_f32 v61, v100, -v101
    ds_write_b64 v6, v[60:61] offset:19584
    v_pk_mul_f32 v[94:95], v[98:99], v[82:83] op_sel:[0,0] op_sel_hi:[0,1]
    v_pk_fma_f32 v[94:95], v[98:99], v[82:83], v[94:95] op_sel:[1,1,0] op_sel_hi:[1,0,1] neg_lo:[0,1,0]
    v_pk_mul_f32 v[96:97], v[100:101], v[84:85] op_sel:[0,0] op_sel_hi:[0,1]
    v_pk_fma_f32 v[96:97], v[100:101], v[84:85], v[96:97] op_sel:[1,1,0] op_sel_hi:[1,0,1] neg_lo:[0,1,0]
    v_cvt_pk_f16_f32 v62, v94, -v95
    v_cvt_pk_f16_f32 v63, v96, -v97
    ds_write_b64 v6, v[62:63] offset:20128
    v_pk_mul_f32 v[98:99], v[94:95], v[82:83] op_sel:[0,0] op_sel_hi:[0,1]
    v_pk_fma_f32 v[98:99], v[94:95], v[82:83], v[98:99] op_sel:[1,1,0] op_sel_hi:[1,0,1] neg_lo:[0,1,0]
    v_pk_mul_f32 v[100:101], v[96:97], v[84:85] op_sel:[0,0] op_sel_hi:[0,1]
    v_pk_fma_f32 v[100:101], v[96:97], v[84:85], v[100:101] op_sel:[1,1,0] op_sel_hi:[1,0,1] neg_lo:[0,1,0]
    v_cvt_pk_f16_f32 v60, v98, -v99
    v_cvt_pk_f16_f32 v61, v100, -v101
    ds_write_b64 v6, v[60:61] offset:20672
    v_pk_mul_f32 v[94:95], v[98:99], v[82:83] op_sel:[0,0] op_sel_hi:[0,1]
    v_pk_fma_f32 v[94:95], v[98:99], v[82:83], v[94:95] op_sel:[1,1,0] op_sel_hi:[1,0,1] neg_lo:[0,1,0]
    v_pk_mul_f32 v[96:97], v[100:101], v[84:85] op_sel:[0,0] op_sel_hi:[0,1]
    v_pk_fma_f32 v[96:97], v[100:101], v[84:85], v[96:97] op_sel:[1,1,0] op_sel_hi:[1,0,1] neg_lo:[0,1,0]
    v_cvt_pk_f16_f32 v62, v94, -v95
    v_cvt_pk_f16_f32 v63, v96, -v97
    ds_write_b64 v6, v[62:63] offset:21216
    v_pk_mul_f32 v[98:99], v[94:95], v[82:83] op_sel:[0,0] op_sel_hi:[0,1]
    v_pk_fma_f32 v[98:99], v[94:95], v[82:83], v[98:99] op_sel:[1,1,0] op_sel_hi:[1,0,1] neg_lo:[0,1,0]
    v_pk_mul_f32 v[100:101], v[96:97], v[84:85] op_sel:[0,0] op_sel_hi:[0,1]
    v_pk_fma_f32 v[100:101], v[96:97], v[84:85], v[100:101] op_sel:[1,1,0] op_sel_hi:[1,0,1] neg_lo:[0,1,0]
    v_cvt_pk_f16_f32 v60, v98, -v99
    v_cvt_pk_f16_f32 v61, v100, -v101
    ds_write_b64 v6, v[60:61] offset:21760
    s_nop 1
KA_RDONE:
    s_waitcnt lgkmcnt(0)
    s_barrier
    s_cmp_ge_u32 s3, 6
    s_cbranch_scc1 KA_MDONE
    ds_read_b128 v[8:11], v124 offset:0
    ds_read_b128 v[12:15], v125 offset:0
    ds_read_b128 v[16:19], v124 offset:64
    ds_read_b128 v[20:23], v125 offset:64
    ds_read_b128 v[24:27], v124 offset:128
    ds_read_b128 v[28:31], v125 offset:128
    ds_read_b128 v[32:35], v124 offset:192
    ds_read_b128 v[36:39], v125 offset:192
    ds_read_b128 v[40:43], v124 offset:256
    ds_read_b128 v[44:47], v125 offset:256
    ds_read_b128 v[48:51], v124 offset:320
    ds_read_b128 v[52:55], v125 offset:320
    ds_read_b128 v[56:59], v124 offset:384
    ds_read_b128 v[60:63], v125 offset:384
    ds_read_b128 v[64:67], v124 offset:448
    ds_read_b128 v[68:71], v125 offset:448
    s_waitcnt lgkmcnt(14)
    v_mfma_f32_16x16x32_f16 v[76:79], v[8:11], v[12:15], 0
    s_waitcnt lgkmcnt(12)
    v_mfma_f32_16x16x32_f16 v[76:79], v[16:19], v[20:23], v[76:79]
    s_waitcnt lgkmcnt(10)
    v_mfma_f32_16x16x32_f16 v[76:79], v[24:27], v[28:31], v[76:79]
    s_waitcnt lgkmcnt(8)
    v_mfma_f32_16x16x32_f16 v[76:79], v[32:35], v[36:39], v[76:79]
    s_waitcnt lgkmcnt(6)
    v_mfma_f32_16x16x32_f16 v[76:79], v[40:43], v[44:47], v[76:79]
    s_waitcnt lgkmcnt(4)
    v_mfma_f32_16x16x32_f16 v[76:79], v[48:51], v[52:55], v[76:79]
    s_waitcnt lgkmcnt(2)
    v_mfma_f32_16x16x32_f16 v[76:79], v[56:59], v[60:63], v[76:79]
    s_waitcnt lgkmcnt(0)
    v_mfma_f32_16x16x32_f16 v[76:79], v[64:67], v[68:71], v[76:79]
    s_mul_i32 s13, s64, 1600
    s_add_u32 s13, s13, 75792
    s_nop 5
    v_cvt_pk_f16_f32 v80, v76, v77
    v_cvt_pk_f16_f32 v81, v78, v79
    s_cmp_eq_u32 s65, 1
    s_nop 1
    s_cbranch_scc1 KA_T1
    s_cmp_eq_u32 s65, 2
    s_cbranch_scc1 KA_T2
    v_lshrrev_b32 v84, 1, v120
    v_lshlrev_b32 v84, 8, v84
    v_and_b32 v85, 1, v120
    v_lshl_add_u32 v84, v85, 3, v84
    v_lshl_add_u32 v84, v121, 4, v84
    v_add_u32 v84, s13, v84
    ds_write_b64 v84, v[80:81]
    s_nop 1
    s_branch KA_MDONE
KA_T1:
    v_cmp_gt_u32 vcc, 2, v120
    v_lshlrev_b32 v84, 3, v121
    v_lshlrev_b32 v85, 2, v121
    v_cndmask_b32 v84, v85, v84, vcc
    v_lshl_add_u32 v84, v120, 7, v84
    v_add_u32 v84, s13, v84
    v_mov_b32 v85, 64
    v_cndmask_b32 v85, v85, 4, vcc
    v_add_u32 v85, v84, v85
    ds_write_b32 v84, v80 offset:512
    ds_write_b32 v85, v81 offset:512
    s_nop 0
    s_branch KA_MDONE
KA_T2:
    v_lshlrev_b32 v84, 1, v121
    v_lshl_add_u32 v84, v120, 7, v84
    v_add_u32 v84, s13, v84
    ds_write_b16 v84, v80 offset:1024
    ds_write_b16_d16_hi v84, v80 offset:1056
    ds_write_b16 v84, v81 offset:1088
    ds_write_b16_d16_hi v84, v81 offset:1120
KA_MDONE:
    s_waitcnt lgkmcnt(0)
    s_barrier
    ds_read_u16 v8, v104
    ds_read_u16 v9, v105
    ds_read_u16 v10, v106
    ds_read_u16 v11, v107
    ds_read_u16 v12, v108
    ds_read_u16 v13, v109
    ds_read_u16 v14, v110
    ds_read_u16 v15, v111
    ds_read_u16 v16, v112
    ds_read_u16 v17, v113
    ds_read_u16 v18, v114
    ds_read_u16 v19, v115
    ds_read_u16 v20, v116
    ds_read_u16 v21, v117
    ds_read_u16 v22, v118
    s_waitcnt lgkmcnt(0)
    v_lshl_or_b32 v24, v9, 16, v8
    v_lshl_or_b32 v25, v11, 16, v10
    v_lshl_or_b32 v26, v13, 16, v12
    v_lshl_or_b32 v27, v15, 16, v14
    v_lshl_or_b32 v28, v17, 16, v16
    v_lshl_or_b32 v29, v19, 16, v18
    ds_write_b128 v119, v[24:27]
    ds_write_b128 v119, v[26:29] offset:16640
    v_lshl_or_b32 v34, v11, 16, v10
    v_lshl_or_b32 v35, v13, 16, v12
    v_lshl_or_b32 v36, v15, 16, v14
    v_lshl_or_b32 v37, v17, 16, v16
    v_lshl_or_b32 v38, v19, 16, v18
    v_lshl_or_b32 v39, v21, 16, v20
    ds_write_b128 v119, v[34:37] offset:8320
    ds_write_b128 v119, v[36:39] offset:24960
    v_lshl_or_b32 v42, v10, 16, v9
    v_lshl_or_b32 v43, v12, 16, v11
    v_lshl_or_b32 v44, v14, 16, v13
    v_lshl_or_b32 v45, v16, 16, v15
    v_lshl_or_b32 v46, v18, 16, v17
    v_lshl_or_b32 v47, v20, 16, v19
    ds_write_b128 v119, v[42:45] offset:4160
    ds_write_b128 v119, v[44:47] offset:20800
    v_lshl_or_b32 v52, v12, 16, v11
    v_lshl_or_b32 v53, v14, 16, v13
    v_lshl_or_b32 v54, v16, 16, v15
    v_lshl_or_b32 v55, v18, 16, v17
    v_lshl_or_b32 v56, v20, 16, v19
    v_lshl_or_b32 v57, v22, 16, v21
    ds_write_b128 v119, v[52:55] offset:12480
    ds_write_b128 v119, v[54:57] offset:29120
    v_mov_b32 v60, 0
    v_mov_b32 v61, 0
    v_mov_b32 v62, 0
    v_mov_b32 v63, 0
    v_mul_u32_u24 v64, 4160, v0
    v_cmp_gt_u32 vcc, 16, v0
    s_nop 1
    s_and_saveexec_b64 s[14:15], vcc
    ds_write_b128 v64, v[60:63] offset:4096
    s_mov_b64 exec, s[14:15]
    s_waitcnt lgkmcnt(0)
    s_barrier
    ds_read_b128 v[8:11], v122 offset:3648
    ds_read_b128 v[40:43], v123 offset:64
    ds_read_b128 v[12:15], v122 offset:3136
    ds_read_b128 v[44:47], v123 offset:576
    ds_read_b128 v[16:19], v122 offset:2624
    ds_read_b128 v[48:51], v123 offset:1088
    ds_read_b128 v[20:23], v122 offset:2112
    ds_read_b128 v[52:55], v123 offset:1600
    ds_read_b128 v[24:27], v122 offset:1600
    ds_read_b128 v[56:59], v123 offset:2112
    ds_read_b128 v[28:31], v122 offset:1088
    ds_read_b128 v[60:63], v123 offset:2624
    ds_read_b128 v[32:35], v122 offset:576
    ds_read_b128 v[64:67], v123 offset:3136
    ds_read_b128 v[36:39], v122 offset:64
    ds_read_b128 v[68:71], v123 offset:3648
    s_waitcnt lgkmcnt(14)
    v_mfma_f32_16x16x32_f16 v[72:75], v[8:11], v[40:43], 0
    s_waitcnt lgkmcnt(12)
    v_mfma_f32_16x16x32_f16 v[76:79], v[8:11], v[44:47], 0
    v_mfma_f32_16x16x32_f16 v[76:79], v[12:15], v[40:43], v[76:79]
    v_mfma_f32_16x16x32_f16 v[80:83], v[12:15], v[44:47], 0
    s_waitcnt lgkmcnt(10)
    v_mfma_f32_16x16x32_f16 v[80:83], v[8:11], v[48:51], v[80:83]
    v_mfma_f32_16x16x32_f16 v[84:87], v[12:15], v[48:51], 0
    v_mfma_f32_16x16x32_f16 v[80:83], v[16:19], v[40:43], v[80:83]
    v_mfma_f32_16x16x32_f16 v[84:87], v[16:19], v[44:47], v[84:87]
    v_mfma_f32_16x16x32_f16 v[88:91], v[16:19], v[48:51], 0
    s_waitcnt lgkmcnt(8)
    v_mfma_f32_16x16x32_f16 v[84:87], v[8:11], v[52:55], v[84:87]
    v_mfma_f32_16x16x32_f16 v[88:91], v[12:15], v[52:55], v[88:91]
    v_mfma_f32_16x16x32_f16 v[92:95], v[16:19], v[52:55], 0
    v_mfma_f32_16x16x32_f16 v[84:87], v[20:23], v[40:43], v[84:87]
    v_mfma_f32_16x16x32_f16 v[88:91], v[20:23], v[44:47], v[88:91]
    v_mfma_f32_16x16x32_f16 v[92:95], v[20:23], v[48:51], v[92:95]
    v_mfma_f32_16x16x32_f16 v[96:99], v[20:23], v[52:55], 0
    s_waitcnt lgkmcnt(6)
    v_mfma_f32_16x16x32_f16 v[88:91], v[8:11], v[56:59], v[88:91]
    v_mfma_f32_16x16x32_f16 v[92:95], v[12:15], v[56:59], v[92:95]
    v_mfma_f32_16x16x32_f16 v[96:99], v[16:19], v[56:59], v[96:99]
    v_mfma_f32_16x16x32_f16 v[100:103], v[20:23], v[56:59], 0
    v_mfma_f32_16x16x32_f16 v[88:91], v[24:27], v[40:43], v[88:91]
    v_mfma_f32_16x16x32_f16 v[92:95], v[24:27], v[44:47], v[92:95]
    v_mfma_f32_16x16x32_f16 v[96:99], v[24:27], v[48:51], v[96:99]
    v_mfma_f32_16x16x32_f16 v[100:103], v[24:27], v[52:55], v[100:103]
    s_waitcnt lgkmcnt(4)
    v_mfma_f32_16x16x32_f16 v[92:95], v[8:11], v[60:63], v[92:95]
    v_mfma_f32_16x16x32_f16 v[96:99], v[12:15], v[60:63], v[96:99]
    v_mfma_f32_16x16x32_f16 v[100:103], v[16:19], v[60:63], v[100:103]
    v_mfma_f32_16x16x32_f16 v[92:95], v[28:31], v[40:43], v[92:95]
    v_mfma_f32_16x16x32_f16 v[96:99], v[28:31], v[44:47], v[96:99]
    v_mfma_f32_16x16x32_f16 v[100:103], v[28:31], v[48:51], v[100:103]
    s_waitcnt lgkmcnt(2)
    v_mfma_f32_16x16x32_f16 v[96:99], v[8:11], v[64:67], v[96:99]
    v_mfma_f32_16x16x32_f16 v[100:103], v[12:15], v[64:67], v[100:103]
    v_mfma_f32_16x16x32_f16 v[96:99], v[32:35], v[40:43], v[96:99]
    v_mfma_f32_16x16x32_f16 v[100:103], v[32:35], v[44:47], v[100:103]
    s_waitcnt lgkmcnt(0)
    v_mfma_f32_16x16x32_f16 v[100:103], v[8:11], v[68:71], v[100:103]
    v_mfma_f32_16x16x32_f16 v[100:103], v[36:39], v[40:43], v[100:103]
    ds_read_b128 v[8:11], v122 offset:3584
    ds_read_b128 v[40:43], v123 offset:0
    ds_read_b128 v[12:15], v122 offset:3072
    ds_read_b128 v[44:47], v123 offset:512
    ds_read_b128 v[16:19], v122 offset:2560
    ds_read_b128 v[48:51], v123 offset:1024
    ds_read_b128 v[20:23], v122 offset:2048
    ds_read_b128 v[52:55], v123 offset:1536
    ds_read_b128 v[24:27], v122 offset:1536
    ds_read_b128 v[56:59], v123 offset:2048
    ds_read_b128 v[28:31], v122 offset:1024
    ds_read_b128 v[60:63], v123 offset:2560
    ds_read_b128 v[32:35], v122 offset:512
    ds_read_b128 v[64:67], v123 offset:3072
    ds_read_b128 v[36:39], v122 offset:0
    ds_read_b128 v[68:71], v123 offset:3584
    s_waitcnt lgkmcnt(14)
    v_mfma_f32_16x16x32_f16 v[72:75], v[8:11], v[40:43], v[72:75]
    s_waitcnt lgkmcnt(12)
    v_mfma_f32_16x16x32_f16 v[76:79], v[8:11], v[44:47], v[76:79]
    v_mfma_f32_16x16x32_f16 v[76:79], v[12:15], v[40:43], v[76:79]
    v_mfma_f32_16x16x32_f16 v[80:83], v[12:15], v[44:47], v[80:83]
    s_waitcnt lgkmcnt(10)
    v_mfma_f32_16x16x32_f16 v[80:83], v[8:11], v[48:51], v[80:83]
    v_mfma_f32_16x16x32_f16 v[84:87], v[12:15], v[48:51], v[84:87]
    v_mfma_f32_16x16x32_f16 v[80:83], v[16:19], v[40:43], v[80:83]
    v_mfma_f32_16x16x32_f16 v[84:87], v[16:19], v[44:47], v[84:87]
    v_mfma_f32_16x16x32_f16 v[88:91], v[16:19], v[48:51], v[88:91]
    s_waitcnt lgkmcnt(8)
    v_mfma_f32_16x16x32_f16 v[84:87], v[8:11], v[52:55], v[84:87]
    v_mfma_f32_16x16x32_f16 v[88:91], v[12:15], v[52:55], v[88:91]
    v_mfma_f32_16x16x32_f16 v[92:95], v[16:19], v[52:55], v[92:95]
    v_mfma_f32_16x16x32_f16 v[84:87], v[20:23], v[40:43], v[84:87]
    v_mfma_f32_16x16x32_f16 v[88:91], v[20:23], v[44:47], v[88:91]
    v_mfma_f32_16x16x32_f16 v[92:95], v[20:23], v[48:51], v[92:95]
    v_mfma_f32_16x16x32_f16 v[96:99], v[20:23], v[52:55], v[96:99]
    s_waitcnt lgkmcnt(6)
    v_mfma_f32_16x16x32_f16 v[88:91], v[8:11], v[56:59], v[88:91]
    v_mfma_f32_16x16x32_f16 v[92:95], v[12:15], v[56:59], v[92:95]
    v_mfma_f32_16x16x32_f16 v[96:99], v[16:19], v[56:59], v[96:99]
    v_mfma_f32_16x16x32_f16 v[100:103], v[20:23], v[56:59], v[100:103]
    v_mfma_f32_16x16x32_f16 v[88:91], v[24:27], v[40:43], v[88:91]
    v_mfma_f32_16x16x32_f16 v[92:95], v[24:27], v[44:47], v[92:95]
    v_mfma_f32_16x16x32_f16 v[96:99], v[24:27], v[48:51], v[96:99]
    v_mfma_f32_16x16x32_f16 v[100:103], v[24:27], v[52:55], v[100:103]
    s_waitcnt lgkmcnt(4)
    v_mfma_f32_16x16x32_f16 v[92:95], v[8:11], v[60:63], v[92:95]
    v_mfma_f32_16x16x32_f16 v[96:99], v[12:15], v[60:63], v[96:99]
    v_mfma_f32_16x16x32_f16 v[100:103], v[16:19], v[60:63], v[100:103]
    v_mfma_f32_16x16x32_f16 v[92:95], v[28:31], v[40:43], v[92:95]
    v_mfma_f32_16x16x32_f16 v[96:99], v[28:31], v[44:47], v[96:99]
    v_mfma_f32_16x16x32_f16 v[100:103], v[28:31], v[48:51], v[100:103]
    s_waitcnt lgkmcnt(2)
    v_mfma_f32_16x16x32_f16 v[96:99], v[8:11], v[64:67], v[96:99]
    v_mfma_f32_16x16x32_f16 v[100:103], v[12:15], v[64:67], v[100:103]
    v_mfma_f32_16x16x32_f16 v[96:99], v[32:35], v[40:43], v[96:99]
    v_mfma_f32_16x16x32_f16 v[100:103], v[32:35], v[44:47], v[100:103]
    s_waitcnt lgkmcnt(0)
    v_mfma_f32_16x16x32_f16 v[100:103], v[8:11], v[68:71], v[100:103]
    v_mfma_f32_16x16x32_f16 v[100:103], v[36:39], v[40:43], v[100:103]
    s_barrier
    s_lshl_b32 s12, s3, 13
    v_add_u32 v7, s12, v3
    ds_write_b128 v7, v[72:75] offset:0
    ds_write_b128 v7, v[76:79] offset:1024
    ds_write_b128 v7, v[80:83] offset:2048
    ds_write_b128 v7, v[84:87] offset:3072
    ds_write_b128 v7, v[88:91] offset:4096
    ds_write_b128 v7, v[92:95] offset:5120
    ds_write_b128 v7, v[96:99] offset:6144
    ds_write_b128 v7, v[100:103] offset:7168
    s_waitcnt lgkmcnt(0)
    s_barrier
    s_endpgm
KA_LG:
    s_setprio 3
    s_mov_b32 s8, s3
    v_and_b32 v4, 0x1ff, v0
    s_lshr_b32 s5, s2, 4
    s_lshl_b32 s5, s5, 3
    s_and_b32 s6, s2, 7
    s_add_u32 s5, s5, s6
    s_bfe_u32 s6, s2, 0x10003
    v_lshrrev_b32 v5, 4, v4
    v_and_b32 v6, 15, v4
    v_mul_u32_u24 v7, 272, v5
    v_lshl_add_u32 v7, v6, 4, v7
    v_add_u32 v7, 79040, v7
    v_lshrrev_b32 v122, 2, v121
    v_and_b32 v123, 3, v121
    v_mov_b32 v8, 0
    v_mov_b32 v9, 0
    v_mov_b32 v124, 78976
    ds_write_b64 v124, v[8:9]
    v_and_b32 v10, 1, v4
    v_mul_u32_u24 v10, 1600, v10
    v_add_u32 v10, 75788, v10
    ds_write_b32 v10, v8
    v_bfe_u32 v10, v4, 7, 1
    v_mul_u32_u24 v10, 4608, v10
    v_and_b32 v11, 127, v4
    v_lshl_add_u32 v10, v11, 2, v10
    v_add_u32 v10, 66560, v10
    ds_write_b32 v10, v8
    s_waitcnt lgkmcnt(0)
    s_mov_b32 s68, s42
    s_and_b32 s69, s43, 0xffff
    s_mov_b32 s70, 268435456
    s_mov_b32 s71, 0x00020000
    s_mov_b32 s72, s40
    s_and_b32 s73, s41, 0xffff
    s_mov_b32 s74, 256
    s_mov_b32 s75, 0x00020000
    s_lshl_b32 s7, s4, 2
    s_load_dword s45, s[28:29], s7
    s_lshl_b32 s78, s2, 7
    s_add_u32 s78, s78, 27328512
    s_mov_b32 s48, s16
    s_and_b32 s49, s17, 0xffff
    s_mov_b32 s50, 2097152
    s_mov_b32 s51, 0x00020000
    s_cmp_lg_u32 s8, 0
    s_cbranch_scc1 KA_NORST
    s_mov_b64 exec, 1
    buffer_store_dwordx2 v[8:9], v8, s[68:71], s78 offen sc1
    s_mov_b64 exec, -1
KA_NORST:
    s_cmp_eq_u32 s6, 1
    s_cbranch_scc1 KA_LW
    v_lshlrev_b32 v10, 10, v5
    v_lshl_add_u32 v10, v6, 4, v10
    s_lshr_b32 s56, s5, 2
    s_and_b32 s57, s5, 3
    s_lshl_b32 s58, s56, 16
    s_lshl_b32 s59, s57, 8
    s_add_u32 s58, s58, s59
    s_add_u32 s59, s58, 32768
    buffer_load_dwordx4 v[12:15], v10, s[48:51], s58 offen
    buffer_load_dwordx4 v[16:19], v10, s[48:51], s59 offen
    s_lshl_b32 s60, s5, 4
    s_lshl_b32 s61, s8, 1
    s_add_u32 s60, s60, s61
    s_lshl_b32 s61, s60, 10
    buffer_load_dwordx4 v[20:23], v3, s[48:51], s61 offen
    buffer_load_dwordx4 v[24:27], v3, s[48:51], s61 offen offset:1024
    v_lshl_add_u32 v11, v120, 3, v122
    v_mul_u32_u24 v11, 272, v11
    v_lshl_add_u32 v11, v123, 3, v11
    s_lshl_b32 s61, s8, 5
    s_add_u32 s61, s61, 79040
    v_add_u32 v11, s61, v11
    v_lshlrev_b32 v28, 12, v121
    v_lshl_add_u32 v28, v120, 4, v28
    s_lshl_b32 s61, s57, 19
    s_lshl_b32 s62, s8, 16
    s_add_u32 s61, s61, s62
    s_lshl_b32 s62, s56, 7
    s_add_u32 s61, s61, s62
    s_add_u32 s61, s61, 2097152
    s_lshl_b32 s62, s60, 3
    s_add_u32 s62, s62, 8552448
    s_waitcnt vmcnt(2)
    ds_write_b128 v7, v[12:15]
    ds_write_b128 v7, v[16:19] offset:8704
    s_waitcnt lgkmcnt(0)
    s_barrier
    ds_read_b64_tr_b16 v[12:13], v11 offset:0
    ds_read_b64_tr_b16 v[14:15], v11 offset:1088
    ds_read_b64_tr_b16 v[16:17], v11 offset:8704
    ds_read_b64_tr_b16 v[18:19], v11 offset:9792
    s_waitcnt vmcnt(0) lgkmcnt(0)
    buffer_store_dwordx4 v[12:15], v28, s[68:71], s61 offen sc1
    buffer_store_dwordx4 v[16:19], v28, s[68:71], s61 offen offset:64 sc1
    v_and_b32 v31, 0xffff0000, v20
    v_lshlrev_b32 v30, 16, v20
    v_and_b32 v33, 0xffff0000, v21
    v_lshlrev_b32 v32, 16, v21
    v_and_b32 v35, 0xffff0000, v22
    v_lshlrev_b32 v34, 16, v22
    v_and_b32 v37, 0xffff0000, v23
    v_lshlrev_b32 v36, 16, v23
    v_and_b32 v39, 0xffff0000, v24
    v_lshlrev_b32 v38, 16, v24
    v_and_b32 v41, 0xffff0000, v25
    v_lshlrev_b32 v40, 16, v25
    v_and_b32 v43, 0xffff0000, v26
    v_lshlrev_b32 v42, 16, v26
    v_and_b32 v45, 0xffff0000, v27
    v_lshlrev_b32 v44, 16, v27
    v_add_f32 v46, v30, v31
    v_add_f32 v47, v32, v33
    v_add_f32 v48, v34, v35
    v_add_f32 v49, v36, v37
    v_add_f32 v46, v46, v47
    v_add_f32 v48, v48, v49
    v_add_f32 v46, v46, v48
    v_add_f32 v50, v38, v39
    v_add_f32 v51, v40, v41
    v_add_f32 v52, v42, v43
    v_add_f32 v53, v44, v45
    v_add_f32 v50, v50, v51
    v_add_f32 v52, v52, v53
    v_add_f32 v50, v50, v52
    v_add_f32_dpp v46, v46, v46 quad_perm:[1,0,3,2] row_mask:0xf bank_mask:0xf
    s_nop 0
    v_add_f32_dpp v50, v50, v50 quad_perm:[1,0,3,2] row_mask:0xf bank_mask:0xf
    v_add_f32_dpp v46, v46, v46 quad_perm:[2,3,0,1] row_mask:0xf bank_mask:0xf
    s_nop 0
    v_add_f32_dpp v50, v50, v50 quad_perm:[2,3,0,1] row_mask:0xf bank_mask:0xf
    v_add_f32_dpp v46, v46, v46 row_half_mirror row_mask:0xf bank_mask:0xf
    s_nop 0
    v_add_f32_dpp v50, v50, v50 row_half_mirror row_mask:0xf bank_mask:0xf
    v_add_f32_dpp v46, v46, v46 row_mirror row_mask:0xf bank_mask:0xf
    s_nop 0
    v_add_f32_dpp v50, v50, v50 row_mirror row_mask:0xf bank_mask:0xf
    v_add_f32_dpp v46, v46, v46 row_bcast:15 row_mask:0xa bank_mask:0xf
    s_nop 0
    v_add_f32_dpp v50, v50, v50 row_bcast:15 row_mask:0xa bank_mask:0xf
    v_add_f32_dpp v46, v46, v46 row_bcast:31 row_mask:0xc bank_mask:0xf
    s_nop 0
    v_add_f32_dpp v50, v50, v50 row_bcast:31 row_mask:0xc bank_mask:0xf
    v_readlane_b32 s14, v46, 63
    v_readlane_b32 s15, v50, 63
    v_mov_b32 v54, 0x3b000000
    v_mul_f32 v47, s14, v54
    v_mul_f32 v51, s15, v54
    v_sub_f32 v30, v30, v47
    v_sub_f32 v31, v31, v47
    v_sub_f32 v32, v32, v47
    v_sub_f32 v33, v33, v47
    v_sub_f32 v34, v34, v47
    v_sub_f32 v35, v35, v47
    v_sub_f32 v36, v36, v47
    v_sub_f32 v37, v37, v47
    v_sub_f32 v38, v38, v51
    v_sub_f32 v39, v39, v51
    v_sub_f32 v40, v40, v51
    v_sub_f32 v41, v41, v51
    v_sub_f32 v42, v42, v51
    v_sub_f32 v43, v43, v51
    v_sub_f32 v44, v44, v51
    v_sub_f32 v45, v45, v51
    v_mul_f32 v46, v30, v30
    v_mul_f32 v48, v31, v31
    v_fmac_f32 v46, v32, v32
    v_fmac_f32 v48, v33, v33
    v_fmac_f32 v46, v34, v34
    v_fmac_f32 v48, v35, v35
    v_fmac_f32 v46, v36, v36
    v_fmac_f32 v48, v37, v37
    v_add_f32 v46, v46, v48
    v_mul_f32 v50, v38, v38
    v_mul_f32 v52, v39, v39
    v_fmac_f32 v50, v40, v40
    v_fmac_f32 v52, v41, v41
    v_fmac_f32 v50, v42, v42
    v_fmac_f32 v52, v43, v43
    v_fmac_f32 v50, v44, v44
    v_fmac_f32 v52, v45, v45
    v_add_f32 v50, v50, v52
    v_add_f32_dpp v46, v46, v46 quad_perm:[1,0,3,2] row_mask:0xf bank_mask:0xf
    s_nop 0
    v_add_f32_dpp v50, v50, v50 quad_perm:[1,0,3,2] row_mask:0xf bank_mask:0xf
    v_add_f32_dpp v46, v46, v46 quad_perm:[2,3,0,1] row_mask:0xf bank_mask:0xf
    s_nop 0
    v_add_f32_dpp v50, v50, v50 quad_perm:[2,3,0,1] row_mask:0xf bank_mask:0xf
    v_add_f32_dpp v46, v46, v46 row_half_mirror row_mask:0xf bank_mask:0xf
    s_nop 0
    v_add_f32_dpp v50, v50, v50 row_half_mirror row_mask:0xf bank_mask:0xf
    v_add_f32_dpp v46, v46, v46 row_mirror row_mask:0xf bank_mask:0xf
    s_nop 0
    v_add_f32_dpp v50, v50, v50 row_mirror row_mask:0xf bank_mask:0xf
    v_add_f32_dpp v46, v46, v46 row_bcast:15 row_mask:0xa bank_mask:0xf
    s_nop 0
    v_add_f32_dpp v50, v50, v50 row_bcast:15 row_mask:0xa bank_mask:0xf
    v_add_f32_dpp v46, v46, v46 row_bcast:31 row_mask:0xc bank_mask:0xf
    s_nop 0
    v_add_f32_dpp v50, v50, v50 row_bcast:31 row_mask:0xc bank_mask:0xf
    v_readlane_b32 s14, v46, 63
    v_readlane_b32 s15, v50, 63
    s_nop 0
    v_mul_f32 v48, s14, v54
    v_mul_f32 v52, s15, v54
    v_cvt_pk_bf16_f32 v55, v48, v52
    v_and_b32 v52, 0xffff0000, v55
    v_lshlrev_b32 v48, 16, v55
    v_add_f32 v48, 0x3727c5ac, v48
    v_add_f32 v52, 0x3727c5ac, v52
    v_cvt_pk_bf16_f32 v55, v48, v52
    v_and_b32 v52, 0xffff0000, v55
    v_lshlrev_b32 v48, 16, v55
    v_sqrt_f32 v48, v48
    v_sqrt_f32 v52, v52
    v_cvt_pk_bf16_f32 v56, v47, v48
    v_cvt_pk_bf16_f32 v58, v51, v52
    v_and_b32 v48, 0xffff0000, v56
    v_and_b32 v52, 0xffff0000, v58
    v_rcp_f32 v57, v48
    v_rcp_f32 v59, v52
    v_mov_b32 v49, 0
    s_mov_b64 exec, 1
    buffer_store_dwordx4 v[56:59], v49, s[68:71], s62 offen sc1
    s_mov_b64 exec, -1
    s_nop 0
    s_branch KA_LJ
KA_LW:
    s_barrier
KA_LJ:
    v_lshlrev_b32 v45, 4, v121
    v_lshl_add_u32 v45, v120, 2, v45
    v_lshlrev_b32 v46, 1, v45
    v_lshlrev_b32 v47, 3, v45
    s_lshl_b32 s56, s4, 13
    s_lshl_b32 s57, s8, 9
    s_add_u32 s56, s56, s57
    s_add_u32 s56, s56, 2097152
    s_add_u32 s58, s56, 4096
    s_lshl_b32 s60, s8, 11
    s_add_u32 s60, s60, 8552448
    v_lshlrev_b32 v44, 16, v122
    v_lshl_add_u32 v44, v123, 5, v44
    v_lshl_add_u32 v44, v120, 3, v44
    s_lshl_b32 s57, s8, 18
    s_lshl_b32 s59, s4, 8
    s_add_u32 s57, s57, s59
    s_add_u32 s57, s57, 9437184
    s_waitcnt vmcnt(0)
    s_mov_b64 exec, 1
    v_mov_b32 v60, 1
    ds_add_rtn_u32 v61, v124, v60
    s_waitcnt lgkmcnt(0)
    v_readfirstlane_b32 s63, v61
    s_nop 1
    s_cmp_lg_u32 s63, 7
    s_nop 1
    s_cbranch_scc1 KA_A1
    s_and_b32 s15, s2, 1
    s_lshl_b32 s14, s15, 7
    v_mov_b32 v61, s14
    buffer_atomic_add v60, v61, s[72:75], 0 offen sc0
    s_nop 1
KA_A1:
    s_mov_b64 exec, -1
    s_barrier
    s_barrier
    s_cmp_lg_u32 s63, 7
    s_cbranch_scc1 KA_A2
    s_mov_b64 exec, 1
    s_waitcnt vmcnt(0)
    v_readfirstlane_b32 s14, v60
    s_nop 1
    s_cmp_lg_u32 s14, 127
    s_nop 1
    s_cbranch_scc1 KA_A2
    v_mov_b32 v60, 1
    v_mov_b32 v61, 64
    buffer_atomic_add v60, v61, s[72:75], 0 offen sc0
    s_waitcnt vmcnt(0)
    v_readfirstlane_b32 s14, v60
    s_nop 1
    s_cmp_lg_u32 s14, 1
    s_nop 1
    s_cbranch_scc1 KA_A2
    s_mov_b64 exec, -1
    v_mov_b32 v60, 1
    v_lshlrev_b32 v61, 7, v2
    s_mov_b32 s14, 27328512
    buffer_store_dword v60, v61, s[68:71], s14 offen sc1
    s_add_u32 s14, s14, 8192
    buffer_store_dword v60, v61, s[68:71], s14 offen sc1
    s_add_u32 s14, s14, 8192
    buffer_store_dword v60, v61, s[68:71], s14 offen sc1
    s_add_u32 s14, s14, 8192
    buffer_store_dword v60, v61, s[68:71], s14 offen sc1
    s_add_u32 s14, s14, 8192
KA_A2:
    s_mov_b64 exec, -1
    s_setprio 3
    s_cmp_lg_u32 s8, 7
    s_cbranch_scc1 KA_SPIN
    v_mov_b32 v54, 0
    s_mov_b32 s14, 0
    s_nop 1
KA_POLL:
    buffer_load_dword v55, v54, s[68:71], s78 offen sc1
    s_waitcnt vmcnt(0)
    v_cmp_ne_u32 vcc, 1, v55
    s_nop 1
    s_cmp_eq_u64 vcc, 0
    s_nop 1
    s_cbranch_scc1 KA_POLLD
    s_add_u32 s14, s14, 1
    s_cmp_ge_u32 s14, 0x20000
    s_cbranch_scc1 KA_POLLD
    s_sleep 1
    s_branch KA_POLL
KA_POLLD:
    v_mov_b32 v55, 1
    ds_write_b32 v124, v55 offset:4
    s_nop 1
    s_branch KA_GO
KA_SPIN:
    ds_read_b32 v55, v124 offset:4
    s_waitcnt lgkmcnt(0)
    v_readfirstlane_b32 s14, v55
    s_nop 1
    s_cmp_eq_u32 s14, 1
    s_nop 1
    s_cbranch_scc1 KA_GO
    s_sleep 1
    s_branch KA_SPIN
KA_GO:
    buffer_load_dwordx2 v[8:9], v46, s[68:71], s56 offen sc1
    buffer_load_dwordx2 v[10:11], v46, s[68:71], s58 offen sc1
    buffer_load_dwordx4 v[12:15], v47, s[68:71], s60 offen sc1
    buffer_load_dwordx4 v[16:19], v47, s[68:71], s60 offen offset:16 sc1
    ds_read_b64 v[48:49], v124 offset:8
    s_lshl_b32 s46, s45, 16
    s_and_b32 s47, s45, 0xffff0000
    s_lshl_b32 s14, s8, 9
    s_add_u32 s14, s14, 67072
    v_add_u32 v47, s14, v46
    s_waitcnt lgkmcnt(0)
    v_readfirstlane_b32 s43, v48
    v_readfirstlane_b32 s44, v49
    s_waitcnt vmcnt(0)
    s_mov_b32 s16, s32
    s_and_b32 s17, s33, 0xffff
    s_mov_b32 s18, 1835008
    s_mov_b32 s19, 0x00020000
    s_mov_b32 s20, s34
    s_and_b32 s21, s35, 0xffff
    s_mov_b32 s22, 1835008
    s_mov_b32 s23, 0x00020000
    s_mov_b32 s64, s36
    s_and_b32 s65, s37, 0xffff
    s_mov_b32 s66, 1835008
    s_mov_b32 s67, 0x00020000
    s_and_b32 s76, s2, 15
    s_lshr_b32 s77, s2, 4
    v_mul_u32_u24 v108, 3584, v5
    v_lshl_add_u32 v108, v6, 4, v108
    v_cmp_gt_u32 vcc, 14, v6
    v_mov_b32 v109, 0x7f000000
    s_nop 0
    v_cndmask_b32 v108, v109, v108, vcc
    s_mul_i32 s24, s77, 114688
    s_mul_i32 s25, s76, 224
    s_add_u32 s24, s24, s25
    buffer_load_dwordx4 v[96:99], v108, s[16:19], s24 offen
    buffer_load_dwordx4 v[100:103], v108, s[20:23], s24 offen
    v_lshlrev_b32 v109, 4, v4
    s_lshl_b32 s24, s2, 13
    buffer_load_dwordx4 v[104:107], v109, s[64:67], s24 offen
    v_lshlrev_b32 v20, 16, v12
    v_and_b32 v24, 0xffff0000, v12
    v_lshlrev_b32 v21, 16, v14
    v_and_b32 v25, 0xffff0000, v14
    v_lshlrev_b32 v22, 16, v16
    v_and_b32 v26, 0xffff0000, v16
    v_lshlrev_b32 v23, 16, v18
    v_and_b32 v27, 0xffff0000, v18
    v_and_b32 v29, 0xffff0000, v8
    v_lshlrev_b32 v28, 16, v8
    v_and_b32 v31, 0xffff0000, v9
    v_lshlrev_b32 v30, 16, v9
    v_and_b32 v33, 0xffff0000, v10
    v_lshlrev_b32 v32, 16, v10
    v_and_b32 v35, 0xffff0000, v11
    v_lshlrev_b32 v34, 16, v11
    v_sub_f32 v50, v28, v20
    v_sub_f32 v51, v29, v21
    v_sub_f32 v52, v30, v22
    v_sub_f32 v53, v31, v23
    v_sub_f32 v54, v32, v20
    v_sub_f32 v55, v33, v21
    v_sub_f32 v56, v34, v22
    v_sub_f32 v57, v35, v23
    v_cvt_pk_bf16_f32 v66, v50, v51
    v_cvt_pk_bf16_f32 v67, v52, v53
    v_cvt_pk_bf16_f32 v68, v54, v55
    v_cvt_pk_bf16_f32 v69, v56, v57
    v_and_b32 v51, 0xffff0000, v66
    v_lshlrev_b32 v50, 16, v66
    v_and_b32 v53, 0xffff0000, v67
    v_lshlrev_b32 v52, 16, v67
    v_and_b32 v55, 0xffff0000, v68
    v_lshlrev_b32 v54, 16, v68
    v_and_b32 v57, 0xffff0000, v69
    v_lshlrev_b32 v56, 16, v69
    v_mul_f32 v58, v50, v13
    v_mul_f32 v59, v51, v15
    v_mul_f32 v60, v52, v17
    v_mul_f32 v61, v53, v19
    v_mul_f32 v62, v54, v13
    v_mul_f32 v63, v55, v15
    v_mul_f32 v64, v56, v17
    v_mul_f32 v65, v57, v19
    v_fma_f32 v50, -v58, v24, v50
    v_fma_f32 v51, -v59, v25, v51
    v_fma_f32 v52, -v60, v26, v52
    v_fma_f32 v53, -v61, v27, v53
    v_fma_f32 v54, -v62, v24, v54
    v_fma_f32 v55, -v63, v25, v55
    v_fma_f32 v56, -v64, v26, v56
    v_fma_f32 v57, -v65, v27, v57
    v_fmac_f32 v58, v50, v13
    v_fmac_f32 v59, v51, v15
    v_fmac_f32 v60, v52, v17
    v_fmac_f32 v61, v53, v19
    v_fmac_f32 v62, v54, v13
    v_fmac_f32 v63, v55, v15
    v_fmac_f32 v64, v56, v17
    v_fmac_f32 v65, v57, v19
    v_cvt_pk_bf16_f32 v66, v58, v59
    v_cvt_pk_bf16_f32 v67, v60, v61
    v_cvt_pk_bf16_f32 v68, v62, v63
    v_cvt_pk_bf16_f32 v69, v64, v65
    v_and_b32 v59, 0xffff0000, v66
    v_lshlrev_b32 v58, 16, v66
    v_and_b32 v61, 0xffff0000, v67
    v_lshlrev_b32 v60, 16, v67
    v_and_b32 v63, 0xffff0000, v68
    v_lshlrev_b32 v62, 16, v68
    v_and_b32 v65, 0xffff0000, v69
    v_lshlrev_b32 v64, 16, v69
    v_cvt_pk_f16_f32 v66, v58, v59
    v_cvt_pk_f16_f32 v67, v60, v61
    v_cvt_pk_f16_f32 v68, v62, v63
    v_cvt_pk_f16_f32 v69, v64, v65
    ds_write_b64 v47, v[66:67]
    ds_write_b64 v47, v[68:69] offset:4608
    s_waitcnt lgkmcnt(0)
    s_setprio 0
    s_barrier
    v_mov_b32 v8, 0
    v_lshlrev_b32 v9, 2, v4
    v_cmp_gt_u32 vcc, 32, v4
    v_mov_b32 v11, 0x7f000000
    s_nop 0
    v_cndmask_b32 v9, v11, v9, vcc
    s_lshl_b32 s14, s2, 7
    s_add_u32 s14, s14, 27262976
    buffer_store_dword v8, v9, s[68:71], s14 offen
    v_mul_f32 v58, s46, v58
    v_mul_f32 v59, s46, v59
    v_mul_f32 v60, s46, v60
    v_mul_f32 v61, s46, v61
    v_mul_f32 v62, s47, v62
    v_mul_f32 v63, s47, v63
    v_mul_f32 v64, s47, v64
    v_mul_f32 v65, s47, v65
    v_cvt_pk_bf16_f32 v70, v58, v59
    v_cvt_pk_bf16_f32 v71, v60, v61
    v_cvt_pk_bf16_f32 v72, v62, v63
    v_cvt_pk_bf16_f32 v73, v64, v65
    v_and_b32 v37, 0xffff0000, v70
    v_lshlrev_b32 v36, 16, v70
    v_and_b32 v39, 0xffff0000, v71
    v_lshlrev_b32 v38, 16, v71
    v_and_b32 v41, 0xffff0000, v72
    v_lshlrev_b32 v40, 16, v72
    v_and_b32 v43, 0xffff0000, v73
    v_lshlrev_b32 v42, 16, v73
    s_mul_i32 s62, s8, 1040
    s_add_u32 s62, s62, 113856
    v_add_u32 v110, s62, v3
    v_lshrrev_b32 v111, 1, v120
    v_lshl_add_u32 v111, v111, 2, v122
    v_mul_u32_u24 v111, 272, v111
    v_and_b32 v115, 1, v120
    v_mul_u32_u24 v115, 17408, v115
    v_add_u32 v111, v111, v115
    v_lshl_add_u32 v111, v123, 3, v111
    s_lshl_b32 s62, s8, 5
    s_add_u32 s62, s62, 79040
    v_add_u32 v111, s62, v111
    v_mul_u32_u24 v112, 1040, v122
    v_lshl_add_u32 v112, v123, 5, v112
    v_lshl_add_u32 v112, v120, 3, v112
    s_lshl_b32 s62, s8, 7
    s_add_u32 s62, s62, 113856
    v_add_u32 v112, s62, v112
    s_mul_i32 s64, s76, 229376
    s_lshl_b32 s65, s8, 15
    s_add_u32 s64, s64, s65
    s_lshl_b32 s65, s77, 11
    s_add_u32 s64, s64, s65
    s_add_u32 s64, s64, 22020096
    s_cmp_ge_u32 s8, 7
    s_cselect_b32 s64, 0x7f000000, s64
    v_lshlrev_b32 v113, 10, v120
    v_lshl_add_u32 v113, v121, 4, v113
    s_mul_i32 s65, s8, 56
    s_lshr_b32 s66, s2, 2
    s_add_u32 s65, s65, s66
    s_lshl_b32 s65, s65, 12
    s_and_b32 s66, s2, 3
    s_lshl_b32 s66, s66, 8
    s_add_u32 s65, s65, s66
    s_add_u32 s65, s65, 19922944
    s_cmp_ge_u32 s2, 224
    s_cselect_b32 s65, 0x7f000000, s65
    s_waitcnt vmcnt(0)
    ds_write_b128 v7, v[96:99]
    ds_write_b128 v7, v[100:103] offset:17408
    ds_write_b128 v110, v[104:107]
    s_lshl_b32 s12, s8, 10
    v_add_u32 v7, s12, v3
    s_waitcnt lgkmcnt(0)
    s_barrier
    ds_read_b64_tr_b16 v[96:97], v111 offset:0
    ds_read_b64_tr_b16 v[98:99], v111 offset:2176
    ds_read_b64_tr_b16 v[100:101], v111 offset:4352
    ds_read_b64_tr_b16 v[102:103], v111 offset:6528
    ds_read_b64_tr_b16 v[104:105], v112
    ds_read_b64_tr_b16 v[106:107], v112 offset:4160
    s_waitcnt lgkmcnt(0)
    buffer_store_dwordx4 v[96:99], v3, s[68:71], s64 offen sc1
    buffer_store_dwordx4 v[100:103], v3, s[68:71], s64 offen offset:1024 sc1
    buffer_store_dwordx4 v[104:107], v113, s[68:71], s65 offen sc1
    s_mov_b32 s67, 0xffff0000
    v_mov_b32 v116, 0
    v_mov_b32 v117, 0
    v_lshlrev_b32 v118, 16, v96
    v_and_b32 v119, s67, v96
    v_add_f32 v116, v116, v118
    v_add_f32 v117, v117, v119
    v_lshlrev_b32 v118, 16, v97
    v_and_b32 v119, s67, v97
    v_add_f32 v116, v116, v118
    v_add_f32 v117, v117, v119
    v_lshlrev_b32 v118, 16, v98
    v_and_b32 v119, s67, v98
    v_add_f32 v116, v116, v118
    v_add_f32 v117, v117, v119
    v_lshlrev_b32 v118, 16, v99
    v_and_b32 v119, s67, v99
    v_add_f32 v116, v116, v118
    v_add_f32 v117, v117, v119
    v_lshlrev_b32 v118, 16, v100
    v_and_b32 v119, s67, v100
    v_add_f32 v116, v116, v118
    v_add_f32 v117, v117, v119
    v_lshlrev_b32 v118, 16, v101
    v_and_b32 v119, s67, v101
    v_add_f32 v116, v116, v118
    v_add_f32 v117, v117, v119
    v_lshlrev_b32 v118, 16, v102
    v_and_b32 v119, s67, v102
    v_add_f32 v116, v116, v118
    v_add_f32 v117, v117, v119
    v_lshlrev_b32 v118, 16, v103
    v_and_b32 v119, s67, v103
    v_add_f32 v116, v116, v118
    v_add_f32 v117, v117, v119
    v_add_f32 v116, v116, v117
    v_mov_b32 v118, v116
    s_nop 1
    v_permlane32_swap_b32 v116, v118
    v_add_f32 v116, v116, v118
    s_mul_i32 s66, s76, 7
    s_add_u32 s66, s66, s8
    s_lshl_b32 s66, s66, 11
    s_lshl_b32 s67, s77, 7
    s_add_u32 s66, s66, s67
    s_add_u32 s66, s66, 26214400
    s_cmp_ge_u32 s8, 7
    s_cselect_b32 s66, 0x7f000000, s66
    v_lshlrev_b32 v114, 2, v2
    s_mov_b64 exec, 0xffffffff
    buffer_store_dword v116, v114, s[68:71], s66 offen
    s_mov_b64 exec, -1
    s_barrier
    ds_read_b128 v[48:51], v7 offset:0
    ds_read_b128 v[52:55], v7 offset:8192
    ds_read_b128 v[56:59], v7 offset:16384
    ds_read_b128 v[60:63], v7 offset:24576
    ds_read_b128 v[64:67], v7 offset:32768
    ds_read_b128 v[68:71], v7 offset:40960
    ds_read_b128 v[72:75], v7 offset:49152
    ds_read_b128 v[76:79], v7 offset:57344
    s_waitcnt lgkmcnt(4)
    v_add_f32 v48, v48, v52
    v_add_f32 v56, v56, v60
    v_add_f32 v49, v49, v53
    v_add_f32 v57, v57, v61
    v_add_f32 v50, v50, v54
    v_add_f32 v58, v58, v62
    v_add_f32 v51, v51, v55
    v_add_f32 v59, v59, v63
    v_add_f32 v48, v48, v56
    v_add_f32 v49, v49, v57
    v_add_f32 v50, v50, v58
    v_add_f32 v51, v51, v59
    v_mul_f32 v48, s43, v48
    v_mul_f32 v49, s43, v49
    v_mul_f32 v50, s43, v50
    v_mul_f32 v51, s43, v51
    v_cvt_pk_bf16_f32 v52, v48, v49
    v_cvt_pk_bf16_f32 v53, v50, v51
    v_and_b32 v49, 0xffff0000, v52
    v_lshlrev_b32 v48, 16, v52
    v_and_b32 v51, 0xffff0000, v53
    v_lshlrev_b32 v50, 16, v53
    v_add_f32 v48, v48, v36
    v_add_f32 v49, v49, v37
    v_add_f32 v50, v50, v38
    v_add_f32 v51, v51, v39
    v_cvt_pk_bf16_f32 v52, v48, v49
    v_cvt_pk_bf16_f32 v53, v50, v51
    v_and_b32 v49, 0xffff0000, v52
    v_lshlrev_b32 v48, 16, v52
    v_and_b32 v51, 0xffff0000, v53
    v_lshlrev_b32 v50, 16, v53
    v_add_f32 v48, v48, v28
    v_add_f32 v49, v49, v29
    v_add_f32 v50, v50, v30
    v_add_f32 v51, v51, v31
    v_cvt_pk_bf16_f32 v52, v48, v49
    v_cvt_pk_bf16_f32 v53, v50, v51
    buffer_store_dwordx2 v[52:53], v44, s[68:71], s57 offen offset:0
    s_waitcnt lgkmcnt(0)
    v_add_f32 v64, v64, v68
    v_add_f32 v72, v72, v76
    v_add_f32 v65, v65, v69
    v_add_f32 v73, v73, v77
    v_add_f32 v66, v66, v70
    v_add_f32 v74, v74, v78
    v_add_f32 v67, v67, v71
    v_add_f32 v75, v75, v79
    v_add_f32 v64, v64, v72
    v_add_f32 v65, v65, v73
    v_add_f32 v66, v66, v74
    v_add_f32 v67, v67, v75
    v_mul_f32 v64, s44, v64
    v_mul_f32 v65, s44, v65
    v_mul_f32 v66, s44, v66
    v_mul_f32 v67, s44, v67
    v_cvt_pk_bf16_f32 v68, v64, v65
    v_cvt_pk_bf16_f32 v69, v66, v67
    v_and_b32 v65, 0xffff0000, v68
    v_lshlrev_b32 v64, 16, v68
    v_and_b32 v67, 0xffff0000, v69
    v_lshlrev_b32 v66, 16, v69
    v_add_f32 v64, v64, v40
    v_add_f32 v65, v65, v41
    v_add_f32 v66, v66, v42
    v_add_f32 v67, v67, v43
    v_cvt_pk_bf16_f32 v68, v64, v65
    v_cvt_pk_bf16_f32 v69, v66, v67
    v_and_b32 v65, 0xffff0000, v68
    v_lshlrev_b32 v64, 16, v68
    v_and_b32 v67, 0xffff0000, v69
    v_lshlrev_b32 v66, 16, v69
    v_add_f32 v64, v64, v32
    v_add_f32 v65, v65, v33
    v_add_f32 v66, v66, v34
    v_add_f32 v67, v67, v35
    v_cvt_pk_bf16_f32 v68, v64, v65
    v_cvt_pk_bf16_f32 v69, v66, v67
    buffer_store_dwordx2 v[68:69], v44, s[68:71], s57 offen offset:128
    s_nop 1
KA_END:
    s_endpgm
.globl kb_mlp_kernel
.p2align 8
.type kb_mlp_kernel,@function
kb_mlp_kernel:
    s_load_dwordx16 s[16:31], s[0:1], 0
    s_load_dwordx8 s[32:39], s[0:1], 64
    s_load_dwordx4 s[40:43], s[0:1], 96
    v_lshrrev_b32 v1, 6, v0
    v_and_b32 v2, 63, v0
    v_readfirstlane_b32 s3, v1
    s_cmp_ge_u32 s2, 256
    s_nop 3
    s_cbranch_scc1 KB_END
    s_and_b32 s4, s2, 7
    s_lshr_b32 s5, s2, 3
    s_and_b32 s6, s4, 1
    s_lshl_b32 s6, s6, 3
    s_and_b32 s7, s5, 7
    s_add_u32 s6, s6, s7
    s_lshr_b32 s7, s4, 1
    s_lshl_b32 s7, s7, 2
    s_lshr_b32 s8, s5, 3
    s_add_u32 s7, s7, s8
    s_cmp_gt_u32 s3, 3
    s_cselect_b32 s15, 1, 0
    s_sub_u32 s15, s3, s15
    v_lshrrev_b32 v3, 4, v2
    v_and_b32 v4, 15, v2
    v_lshlrev_b32 v5, 4, v2
    v_lshrrev_b32 v8, 3, v2
    v_and_b32 v9, 7, v2
    v_and_b32 v10, 2, v8
    v_lshlrev_b32 v10, 1, v10
    v_xor_b32 v9, v9, v10
    v_lshlrev_b32 v6, 7, v8
    v_lshl_add_u32 v6, v9, 4, v6
    s_lshl_b32 s10, s6, 17
    s_lshl_b32 s12, s3, 10
    s_add_u32 s10, s10, s12
    s_add_u32 s10, s10, 9437184
    s_mul_i32 s11, s7, 229376
    s_lshl_b32 s9, s15, 15
    s_add_u32 s11, s11, s9
    s_add_u32 s11, s11, 22020096
    s_waitcnt lgkmcnt(0)
    s_mov_b32 s68, s42
    s_and_b32 s69, s43, 0xffff
    s_mov_b32 s70, 268435456
    s_mov_b32 s71, 0x00020000
    s_cmp_eq_u32 s3, 3
    s_cbranch_scc1 KB_W7
    s_add_u32 m0, s12, 0
    s_add_u32 s9, s10, 0
    buffer_load_dwordx4 v6, s[68:71], s9 offen lds
    s_add_u32 m0, s12, 8192
    s_add_u32 s9, s10, 8192
    buffer_load_dwordx4 v6, s[68:71], s9 offen lds
    s_add_u32 s13, s11, 0
    buffer_load_dwordx4 v[128:131], v5, s[68:71], s13 offen offset:0
    buffer_load_dwordx4 v[132:135], v5, s[68:71], s13 offen offset:1024
    s_add_u32 s13, s11, 2048
    buffer_load_dwordx4 v[136:139], v5, s[68:71], s13 offen offset:0
    buffer_load_dwordx4 v[140:143], v5, s[68:71], s13 offen offset:1024
    s_barrier
    s_add_u32 m0, s12, 16384
    s_add_u32 s9, s10, 16384
    buffer_load_dwordx4 v6, s[68:71], s9 offen lds
    s_add_u32 m0, s12, 24576
    s_add_u32 s9, s10, 24576
    buffer_load_dwordx4 v6, s[68:71], s9 offen lds
    s_add_u32 s13, s11, 4096
    buffer_load_dwordx4 v[144:147], v5, s[68:71], s13 offen offset:0
    buffer_load_dwordx4 v[148:151], v5, s[68:71], s13 offen offset:1024
    s_add_u32 s13, s11, 6144
    buffer_load_dwordx4 v[152:155], v5, s[68:71], s13 offen offset:0
    buffer_load_dwordx4 v[156:159], v5, s[68:71], s13 offen offset:1024
    v_lshrrev_b32 v8, 2, v4
    v_and_b32 v9, 3, v4
    v_lshrrev_b32 v10, 1, v3
    v_lshl_add_u32 v10, v10, 2, v8
    v_and_b32 v11, 1, v3
    v_and_b32 v12, 2, v10
    v_xor_b32 v11, v11, v12
    v_lshlrev_b32 v12, 3, v9
    v_lshl_add_u32 v12, v10, 7, v12
    v_lshl_add_u32 v104, v11, 5, v12
    v_xor_b32 v105, 64, v104
    v_add_u32 v106, 0x10000, v104
    v_add_u32 v107, 0x10000, v105
    s_waitcnt vmcnt(10) lgkmcnt(0)
    s_barrier
    ds_read_b64_tr_b16 v[80:81], v104 offset:0
    ds_read_b64_tr_b16 v[82:83], v104 offset:1024
    ds_read_b64_tr_b16 v[84:85], v105 offset:0
    ds_read_b64_tr_b16 v[86:87], v105 offset:1024
    ds_read_b64_tr_b16 v[88:89], v104 offset:2048
    ds_read_b64_tr_b16 v[90:91], v104 offset:3072
    s_waitcnt vmcnt(8)
    s_waitcnt lgkmcnt(4)
    v_mfma_f32_32x32x16_bf16 v[16:31], v[128:131], v[80:83], 0
    ds_read_b64_tr_b16 v[92:93], v105 offset:2048
    ds_read_b64_tr_b16 v[94:95], v105 offset:3072
    s_add_u32 m0, s12, 32768
    s_add_u32 s9, s10, 32768
    buffer_load_dwordx4 v6, s[68:71], s9 offen lds
    s_waitcnt lgkmcnt(4)
    v_mfma_f32_32x32x16_bf16 v[32:47], v[128:131], v[84:87], 0
    ds_read_b64_tr_b16 v[96:97], v104 offset:4096
    ds_read_b64_tr_b16 v[98:99], v104 offset:5120
    s_add_u32 s13, s11, 8192
    buffer_load_dwordx4 v[160:163], v5, s[68:71], s13 offen offset:0
    buffer_load_dwordx4 v[164:167], v5, s[68:71], s13 offen offset:1024
    s_mov_b32 s48, s38
    s_and_b32 s49, s39, 0xffff
    s_mov_b32 s50, 2097152
    s_mov_b32 s51, 0x00020000
    s_lshl_b32 s60, s4, 1
    s_lshr_b32 s9, s5, 4
    s_add_u32 s60, s60, s9
    s_bfe_u32 s58, s5, 0x10003
    s_and_b32 s61, s5, 7
    s_mul_i32 s62, s61, 56
    s_mul_i32 s9, s3, 7
    s_add_u32 s62, s62, s9
    s_lshl_b32 s62, s62, 12
    s_add_u32 s62, s62, 19922944
    s_lshl_b32 s63, s60, 3
    s_lshl_b32 s14, s58, 1
    s_add_u32 s63, s63, s14
    s_mul_i32 s63, s63, 57344
    s_add_u32 s63, s63, 11534336
    s_mul_i32 s9, s3, 7168
    s_add_u32 s63, s63, s9
    s_lshl_b32 s57, s3, 13
    s_lshl_b32 s66, s6, 11
    s_lshl_b32 s14, s7, 2
    s_add_u32 s66, s66, s14
    s_add_u32 s66, s66, 27262976
    s_lshl_b32 s67, s60, 4
    s_lshl_b32 s9, s58, 3
    s_add_u32 s67, s67, s9
    s_add_u32 s67, s67, s61
    s_lshl_b32 s67, s67, 7
    s_add_u32 s67, s67, 27262976
    v_lshrrev_b32 v9, 1, v3
    v_and_b32 v7, 31, v2
    v_lshlrev_b32 v7, 3, v7
    v_add_u32 v7, 131072, v7
    v_and_b32 v10, 1, v3
    v_mul_u32_u24 v2, 57344, v10
    v_lshl_add_u32 v2, v9, 8, v2
    v_lshl_add_u32 v2, v4, 4, v2
    s_lshl_b32 s59, s6, 3
    s_mul_i32 s59, s59, 57344
    s_mul_i32 s9, s7, 7
    s_add_u32 s9, s9, s15
    s_lshl_b32 s9, s9, 9
    s_add_u32 s59, s59, s9
    s_add_u32 s59, s59, 11534336
    s_mul_i32 s9, s7, 7
    s_add_u32 s9, s9, s15
    s_lshl_b32 s9, s9, 11
    s_add_u32 s9, s9, 26214400
    buffer_load_dwordx4 v[112:115], v5, s[68:71], s9 offen
    buffer_load_dwordx4 v[116:119], v5, s[68:71], s9 offen offset:1024
    s_waitcnt lgkmcnt(4)
    v_mfma_f32_32x32x16_bf16 v[16:31], v[132:135], v[88:91], v[16:31]
    ds_read_b64_tr_b16 v[100:101], v105 offset:4096
    ds_read_b64_tr_b16 v[102:103], v105 offset:5120
    s_add_u32 m0, s12, 40960
    s_add_u32 s9, s10, 40960
    buffer_load_dwordx4 v6, s[68:71], s9 offen lds
    s_waitcnt lgkmcnt(4)
    v_mfma_f32_32x32x16_bf16 v[32:47], v[132:135], v[92:95], v[32:47]
    ds_read_b64_tr_b16 v[80:81], v104 offset:6144
    ds_read_b64_tr_b16 v[82:83], v104 offset:7168
    s_add_u32 s13, s11, 10240
    buffer_load_dwordx4 v[168:171], v5, s[68:71], s13 offen offset:0
    buffer_load_dwordx4 v[172:175], v5, s[68:71], s13 offen offset:1024
    s_waitcnt vmcnt(14)
    s_waitcnt lgkmcnt(4)
    v_mfma_f32_32x32x16_bf16 v[16:31], v[136:139], v[96:99], v[16:31]
    ds_read_b64_tr_b16 v[84:85], v105 offset:6144
    ds_read_b64_tr_b16 v[86:87], v105 offset:7168
    s_waitcnt lgkmcnt(4)
    v_mfma_f32_32x32x16_bf16 v[32:47], v[136:139], v[100:103], v[32:47]
    ds_read_b64_tr_b16 v[88:89], v104 offset:8192
    ds_read_b64_tr_b16 v[90:91], v104 offset:9216
    s_add_u32 m0, s12, 49152
    s_add_u32 s9, s10, 49152
    buffer_load_dwordx4 v6, s[68:71], s9 offen lds
    s_add_u32 s13, s11, 12288
    buffer_load_dwordx4 v[176:179], v5, s[68:71], s13 offen offset:0
    buffer_load_dwordx4 v[180:183], v5, s[68:71], s13 offen offset:1024
    s_waitcnt lgkmcnt(4)
    v_mfma_f32_32x32x16_bf16 v[16:31], v[140:143], v[80:83], v[16:31]
    ds_read_b64_tr_b16 v[92:93], v105 offset:8192
    ds_read_b64_tr_b16 v[94:95], v105 offset:9216
    s_waitcnt lgkmcnt(4)
    v_mfma_f32_32x32x16_bf16 v[32:47], v[140:143], v[84:87], v[32:47]
    ds_read_b64_tr_b16 v[96:97], v104 offset:10240
    ds_read_b64_tr_b16 v[98:99], v104 offset:11264
    s_add_u32 s13, s11, 14336
    buffer_load_dwordx4 v[184:187], v5, s[68:71], s13 offen offset:0
    buffer_load_dwordx4 v[188:191], v5, s[68:71], s13 offen offset:1024
    s_waitcnt vmcnt(15)
    s_waitcnt lgkmcnt(4)
    v_mfma_f32_32x32x16_bf16 v[16:31], v[144:147], v[88:91], v[16:31]
    ds_read_b64_tr_b16 v[100:101], v105 offset:10240
    ds_read_b64_tr_b16 v[102:103], v105 offset:11264
    s_waitcnt lgkmcnt(4)
    v_mfma_f32_32x32x16_bf16 v[32:47], v[144:147], v[92:95], v[32:47]
    ds_read_b64_tr_b16 v[80:81], v104 offset:12288
    ds_read_b64_tr_b16 v[82:83], v104 offset:13312
    s_add_u32 m0, s12, 57344
    s_add_u32 s9, s10, 57344
    buffer_load_dwordx4 v6, s[68:71], s9 offen lds
    s_waitcnt lgkmcnt(4)
    v_mfma_f32_32x32x16_bf16 v[16:31], v[148:151], v[96:99], v[16:31]
    ds_read_b64_tr_b16 v[84:85], v105 offset:12288
    ds_read_b64_tr_b16 v[86:87], v105 offset:13312
    s_waitcnt lgkmcnt(4)
    v_mfma_f32_32x32x16_bf16 v[32:47], v[148:151], v[100:103], v[32:47]
    ds_read_b64_tr_b16 v[88:89], v104 offset:14336
    ds_read_b64_tr_b16 v[90:91], v104 offset:15360
    s_add_u32 s13, s11, 16384
    buffer_load_dwordx4 v[192:195], v5, s[68:71], s13 offen offset:0
    buffer_load_dwordx4 v[196:199], v5, s[68:71], s13 offen offset:1024
    s_waitcnt vmcnt(16)
    s_waitcnt lgkmcnt(4)
    v_mfma_f32_32x32x16_bf16 v[16:31], v[152:155], v[80:83], v[16:31]
    ds_read_b64_tr_b16 v[92:93], v105 offset:14336
    ds_read_b64_tr_b16 v[94:95], v105 offset:15360
    s_waitcnt vmcnt(20)
    s_barrier
    s_waitcnt lgkmcnt(4)
    v_mfma_f32_32x32x16_bf16 v[32:47], v[152:155], v[84:87], v[32:47]
    ds_read_b64_tr_b16 v[96:97], v104 offset:16384
    ds_read_b64_tr_b16 v[98:99], v104 offset:17408
    s_waitcnt lgkmcnt(4)
    v_mfma_f32_32x32x16_bf16 v[16:31], v[156:159], v[88:91], v[16:31]
    ds_read_b64_tr_b16 v[100:101], v105 offset:16384
    ds_read_b64_tr_b16 v[102:103], v105 offset:17408
    s_waitcnt lgkmcnt(4)
    v_mfma_f32_32x32x16_bf16 v[32:47], v[156:159], v[92:95], v[32:47]
    ds_read_b64_tr_b16 v[80:81], v104 offset:18432
    ds_read_b64_tr_b16 v[82:83], v104 offset:19456
    s_add_u32 s13, s11, 18432
    buffer_load_dwordx4 v[200:203], v5, s[68:71], s13 offen offset:0
    buffer_load_dwordx4 v[204:207], v5, s[68:71], s13 offen offset:1024
    s_waitcnt vmcnt(15)
    s_waitcnt lgkmcnt(4)
    v_mfma_f32_32x32x16_bf16 v[16:31], v[160:163], v[96:99], v[16:31]
    ds_read_b64_tr_b16 v[84:85], v105 offset:18432
    ds_read_b64_tr_b16 v[86:87], v105 offset:19456
    s_waitcnt lgkmcnt(4)
    v_mfma_f32_32x32x16_bf16 v[32:47], v[160:163], v[100:103], v[32:47]
    ds_read_b64_tr_b16 v[88:89], v104 offset:20480
    ds_read_b64_tr_b16 v[90:91], v104 offset:21504
    s_waitcnt lgkmcnt(4)
    v_mfma_f32_32x32x16_bf16 v[16:31], v[164:167], v[80:83], v[16:31]
    ds_read_b64_tr_b16 v[92:93], v105 offset:20480
    ds_read_b64_tr_b16 v[94:95], v105 offset:21504
    s_waitcnt lgkmcnt(4)
    v_mfma_f32_32x32x16_bf16 v[32:47], v[164:167], v[84:87], v[32:47]
    ds_read_b64_tr_b16 v[96:97], v104 offset:22528
    ds_read_b64_tr_b16 v[98:99], v104 offset:23552
    s_add_u32 s13, s11, 20480
    buffer_load_dwordx4 v[208:211], v5, s[68:71], s13 offen offset:0
    buffer_load_dwordx4 v[212:215], v5, s[68:71], s13 offen offset:1024
    s_waitcnt vmcnt(12)
    s_waitcnt lgkmcnt(4)
    v_mfma_f32_32x32x16_bf16 v[16:31], v[168:171], v[88:91], v[16:31]
    ds_read_b64_tr_b16 v[100:101], v105 offset:22528
    ds_read_b64_tr_b16 v[102:103], v105 offset:23552
    s_waitcnt lgkmcnt(4)
    v_mfma_f32_32x32x16_bf16 v[32:47], v[168:171], v[92:95], v[32:47]
    ds_read_b64_tr_b16 v[80:81], v104 offset:24576
    ds_read_b64_tr_b16 v[82:83], v104 offset:25600
    s_waitcnt lgkmcnt(4)
    v_mfma_f32_32x32x16_bf16 v[16:31], v[172:175], v[96:99], v[16:31]
    ds_read_b64_tr_b16 v[84:85], v105 offset:24576
    ds_read_b64_tr_b16 v[86:87], v105 offset:25600
    s_waitcnt lgkmcnt(4)
    v_mfma_f32_32x32x16_bf16 v[32:47], v[172:175], v[100:103], v[32:47]
    ds_read_b64_tr_b16 v[88:89], v104 offset:26624
    ds_read_b64_tr_b16 v[90:91], v104 offset:27648
    s_add_u32 s13, s11, 22528
    buffer_load_dwordx4 v[216:219], v5, s[68:71], s13 offen offset:0
    buffer_load_dwordx4 v[220:223], v5, s[68:71], s13 offen offset:1024
    s_waitcnt vmcnt(11)
    s_waitcnt lgkmcnt(4)
    v_mfma_f32_32x32x16_bf16 v[16:31], v[176:179], v[80:83], v[16:31]
    ds_read_b64_tr_b16 v[92:93], v105 offset:26624
    ds_read_b64_tr_b16 v[94:95], v105 offset:27648
    s_waitcnt lgkmcnt(4)
    v_mfma_f32_32x32x16_bf16 v[32:47], v[176:179], v[84:87], v[32:47]
    ds_read_b64_tr_b16 v[96:97], v104 offset:28672
    ds_read_b64_tr_b16 v[98:99], v104 offset:29696
    s_waitcnt lgkmcnt(4)
    v_mfma_f32_32x32x16_bf16 v[16:31], v[180:183], v[88:91], v[16:31]
    ds_read_b64_tr_b16 v[100:101], v105 offset:28672
    ds_read_b64_tr_b16 v[102:103], v105 offset:29696
    s_waitcnt lgkmcnt(4)
    v_mfma_f32_32x32x16_bf16 v[32:47], v[180:183], v[92:95], v[32:47]
    ds_read_b64_tr_b16 v[80:81], v104 offset:30720
    ds_read_b64_tr_b16 v[82:83], v104 offset:31744
    s_add_u32 s13, s11, 24576
    buffer_load_dwordx4 v[224:227], v5, s[68:71], s13 offen offset:0
    buffer_load_dwordx4 v[228:231], v5, s[68:71], s13 offen offset:1024
    s_waitcnt vmcnt(11)
    s_waitcnt lgkmcnt(4)
    v_mfma_f32_32x32x16_bf16 v[16:31], v[184:187], v[96:99], v[16:31]
    ds_read_b64_tr_b16 v[84:85], v105 offset:30720
    ds_read_b64_tr_b16 v[86:87], v105 offset:31744
    s_waitcnt vmcnt(10)
    s_barrier
    s_waitcnt lgkmcnt(4)
    v_mfma_f32_32x32x16_bf16 v[32:47], v[184:187], v[100:103], v[32:47]
    ds_read_b64_tr_b16 v[88:89], v104 offset:32768
    ds_read_b64_tr_b16 v[90:91], v104 offset:33792
    s_waitcnt lgkmcnt(4)
    v_mfma_f32_32x32x16_bf16 v[16:31], v[188:191], v[80:83], v[16:31]
    ds_read_b64_tr_b16 v[92:93], v105 offset:32768
    ds_read_b64_tr_b16 v[94:95], v105 offset:33792
    s_waitcnt lgkmcnt(4)
    v_mfma_f32_32x32x16_bf16 v[32:47], v[188:191], v[84:87], v[32:47]
    ds_read_b64_tr_b16 v[96:97], v104 offset:34816
    ds_read_b64_tr_b16 v[98:99], v104 offset:35840
    s_add_u32 s13, s11, 26624
    buffer_load_dwordx4 v[232:235], v5, s[68:71], s13 offen offset:0
    buffer_load_dwordx4 v[236:239], v5, s[68:71], s13 offen offset:1024
    s_waitcnt vmcnt(10)
    s_waitcnt lgkmcnt(4)
    v_mfma_f32_32x32x16_bf16 v[16:31], v[192:195], v[88:91], v[16:31]
    ds_read_b64_tr_b16 v[100:101], v105 offset:34816
    ds_read_b64_tr_b16 v[102:103], v105 offset:35840
    s_waitcnt lgkmcnt(4)
    v_mfma_f32_32x32x16_bf16 v[32:47], v[192:195], v[92:95], v[32:47]
    ds_read_b64_tr_b16 v[80:81], v104 offset:36864
    ds_read_b64_tr_b16 v[82:83], v104 offset:37888
    s_waitcnt lgkmcnt(4)
    v_mfma_f32_32x32x16_bf16 v[16:31], v[196:199], v[96:99], v[16:31]
    ds_read_b64_tr_b16 v[84:85], v105 offset:36864
    ds_read_b64_tr_b16 v[86:87], v105 offset:37888
    s_waitcnt lgkmcnt(4)
    v_mfma_f32_32x32x16_bf16 v[32:47], v[196:199], v[100:103], v[32:47]
    ds_read_b64_tr_b16 v[88:89], v104 offset:38912
    ds_read_b64_tr_b16 v[90:91], v104 offset:39936
    s_add_u32 s13, s11, 28672
    buffer_load_dwordx4 v[240:243], v5, s[68:71], s13 offen offset:0
    buffer_load_dwordx4 v[244:247], v5, s[68:71], s13 offen offset:1024
    s_waitcnt vmcnt(10)
    s_waitcnt lgkmcnt(4)
    v_mfma_f32_32x32x16_bf16 v[16:31], v[200:203], v[80:83], v[16:31]
    ds_read_b64_tr_b16 v[92:93], v105 offset:38912
    ds_read_b64_tr_b16 v[94:95], v105 offset:39936
    s_waitcnt lgkmcnt(4)
    v_mfma_f32_32x32x16_bf16 v[32:47], v[200:203], v[84:87], v[32:47]
    ds_read_b64_tr_b16 v[96:97], v104 offset:40960
    ds_read_b64_tr_b16 v[98:99], v104 offset:41984
    s_waitcnt lgkmcnt(4)
    v_mfma_f32_32x32x16_bf16 v[16:31], v[204:207], v[88:91], v[16:31]
    ds_read_b64_tr_b16 v[100:101], v105 offset:40960
    ds_read_b64_tr_b16 v[102:103], v105 offset:41984
    s_waitcnt lgkmcnt(4)
    v_mfma_f32_32x32x16_bf16 v[32:47], v[204:207], v[92:95], v[32:47]
    ds_read_b64_tr_b16 v[80:81], v104 offset:43008
    ds_read_b64_tr_b16 v[82:83], v104 offset:44032
    s_add_u32 s13, s11, 30720
    buffer_load_dwordx4 v[248:251], v5, s[68:71], s13 offen offset:0
    buffer_load_dwordx4 v[252:255], v5, s[68:71], s13 offen offset:1024
    s_waitcnt vmcnt(10)
    s_lshl_b32 s46, s3, 7
    s_add_u32 s46, s46, 132160
    s_waitcnt lgkmcnt(4)
    v_mfma_f32_32x32x16_bf16 v[16:31], v[208:211], v[96:99], v[16:31]
    ds_read_b64_tr_b16 v[84:85], v105 offset:43008
    ds_read_b64_tr_b16 v[86:87], v105 offset:44032
    v_add_f32 v112, v112, v116
    v_add_f32 v113, v113, v117
    v_add_f32 v114, v114, v118
    v_add_f32 v115, v115, v119
    s_waitcnt lgkmcnt(4)
    v_mfma_f32_32x32x16_bf16 v[32:47], v[208:211], v[100:103], v[32:47]
    ds_read_b64_tr_b16 v[88:89], v104 offset:45056
    ds_read_b64_tr_b16 v[90:91], v104 offset:46080
    v_add_f32_dpp v112, v112, v112 row_ror:8 row_mask:0xf bank_mask:0xf
    v_add_f32_dpp v113, v113, v113 row_ror:8 row_mask:0xf bank_mask:0xf
    v_add_f32_dpp v114, v114, v114 row_ror:8 row_mask:0xf bank_mask:0xf
    v_add_f32_dpp v115, v115, v115 row_ror:8 row_mask:0xf bank_mask:0xf
    s_waitcnt lgkmcnt(4)
    v_mfma_f32_32x32x16_bf16 v[16:31], v[212:215], v[80:83], v[16:31]
    ds_read_b64_tr_b16 v[92:93], v105 offset:45056
    ds_read_b64_tr_b16 v[94:95], v105 offset:46080
    s_add_u32 m0, s12, 65536
    s_add_u32 s9, s10, 65536
    buffer_load_dwordx4 v6, s[68:71], s9 offen lds
    v_mov_b32 v116, v112
    v_mov_b32 v117, v113
    v_mov_b32 v118, v114
    v_mov_b32 v119, v115
    s_waitcnt lgkmcnt(4)
    v_mfma_f32_32x32x16_bf16 v[32:47], v[212:215], v[84:87], v[32:47]
    ds_read_b64_tr_b16 v[96:97], v104 offset:47104
    ds_read_b64_tr_b16 v[98:99], v104 offset:48128
    v_permlane16_swap_b32 v112, v116
    v_permlane16_swap_b32 v113, v117
    v_permlane16_swap_b32 v114, v118
    v_permlane16_swap_b32 v115, v119
    s_waitcnt vmcnt(9)
    s_waitcnt lgkmcnt(4)
    v_mfma_f32_32x32x16_bf16 v[16:31], v[216:219], v[88:91], v[16:31]
    ds_read_b64_tr_b16 v[100:101], v105 offset:47104
    ds_read_b64_tr_b16 v[102:103], v105 offset:48128
    s_add_u32 m0, s12, 73728
    s_add_u32 s9, s10, 73728
    buffer_load_dwordx4 v6, s[68:71], s9 offen lds
    v_add_f32 v112, v112, v116
    v_add_f32 v113, v113, v117
    v_add_f32 v114, v114, v118
    v_add_f32 v115, v115, v119
    s_waitcnt lgkmcnt(4)
    v_mfma_f32_32x32x16_bf16 v[32:47], v[216:219], v[92:95], v[32:47]
    ds_read_b64_tr_b16 v[80:81], v104 offset:49152
    ds_read_b64_tr_b16 v[82:83], v104 offset:50176
    v_mov_b32 v116, v112
    v_mov_b32 v117, v113
    v_mov_b32 v118, v114
    v_mov_b32 v119, v115
    s_waitcnt lgkmcnt(4)
    v_mfma_f32_32x32x16_bf16 v[16:31], v[220:223], v[96:99], v[16:31]
    ds_read_b64_tr_b16 v[84:85], v105 offset:49152
    ds_read_b64_tr_b16 v[86:87], v105 offset:50176
    s_add_u32 m0, s12, 81920
    s_add_u32 s9, s10, 81920
    buffer_load_dwordx4 v6, s[68:71], s9 offen lds
    v_permlane32_swap_b32 v112, v116
    v_permlane32_swap_b32 v113, v117
    v_permlane32_swap_b32 v114, v118
    v_permlane32_swap_b32 v115, v119
    s_waitcnt lgkmcnt(4)
    v_mfma_f32_32x32x16_bf16 v[32:47], v[220:223], v[100:103], v[32:47]
    ds_read_b64_tr_b16 v[88:89], v104 offset:51200
    ds_read_b64_tr_b16 v[90:91], v104 offset:52224
    v_add_f32 v112, v112, v116
    v_add_f32 v113, v113, v117
    v_add_f32 v114, v114, v118
    v_add_f32 v115, v115, v119
    s_waitcnt vmcnt(9)
    s_waitcnt lgkmcnt(4)
    v_mfma_f32_32x32x16_bf16 v[16:31], v[224:227], v[80:83], v[16:31]
    ds_read_b64_tr_b16 v[92:93], v105 offset:51200
    ds_read_b64_tr_b16 v[94:95], v105 offset:52224
    s_add_u32 m0, s12, 90112
    s_add_u32 s9, s10, 90112
    buffer_load_dwordx4 v6, s[68:71], s9 offen lds
    v_and_b32 v8, 0x70, v5
    v_add_u32 v8, s46, v8
    ds_write_b128 v8, v[112:115]
    v_lshrrev_b32 v9, 1, v3
    s_waitcnt lgkmcnt(4)
    v_mfma_f32_32x32x16_bf16 v[32:47], v[224:227], v[84:87], v[32:47]
    ds_read_b64_tr_b16 v[96:97], v104 offset:53248
    ds_read_b64_tr_b16 v[98:99], v104 offset:54272
    v_lshlrev_b32 v9, 4, v9
    v_add_u32 v9, s46, v9
    ds_read_b128 v[112:115], v9 offset:0
    ds_read_b128 v[116:119], v9 offset:32
    s_waitcnt lgkmcnt(4)
    v_mfma_f32_32x32x16_bf16 v[16:31], v[228:231], v[88:91], v[16:31]
    ds_read_b64_tr_b16 v[100:101], v105 offset:53248
    ds_read_b64_tr_b16 v[102:103], v105 offset:54272
    s_add_u32 m0, s12, 98304
    s_add_u32 s9, s10, 98304
    buffer_load_dwordx4 v6, s[68:71], s9 offen lds
    ds_read_b128 v[120:123], v9 offset:64
    ds_read_b128 v[124:127], v9 offset:96
    s_waitcnt lgkmcnt(4)
    v_mfma_f32_32x32x16_bf16 v[32:47], v[228:231], v[92:95], v[32:47]
    ds_read_b64_tr_b16 v[80:81], v104 offset:55296
    ds_read_b64_tr_b16 v[82:83], v104 offset:56320
    s_waitcnt vmcnt(9)
    s_waitcnt lgkmcnt(4)
    v_mfma_f32_32x32x16_bf16 v[16:31], v[232:235], v[96:99], v[16:31]
    ds_read_b64_tr_b16 v[84:85], v105 offset:55296
    ds_read_b64_tr_b16 v[86:87], v105 offset:56320
    s_add_u32 m0, s12, 106496
    s_add_u32 s9, s10, 106496
    buffer_load_dwordx4 v6, s[68:71], s9 offen lds
    s_waitcnt lgkmcnt(4)
    v_mfma_f32_32x32x16_bf16 v[32:47], v[232:235], v[100:103], v[32:47]
    ds_read_b64_tr_b16 v[88:89], v104 offset:57344
    ds_read_b64_tr_b16 v[90:91], v104 offset:58368
    s_waitcnt lgkmcnt(4)
    v_mfma_f32_32x32x16_bf16 v[16:31], v[236:239], v[80:83], v[16:31]
    ds_read_b64_tr_b16 v[92:93], v105 offset:57344
    ds_read_b64_tr_b16 v[94:95], v105 offset:58368
    s_add_u32 m0, s12, 114688
    s_add_u32 s9, s10, 114688
    buffer_load_dwordx4 v6, s[68:71], s9 offen lds
    s_waitcnt lgkmcnt(4)
    v_mfma_f32_32x32x16_bf16 v[32:47], v[236:239], v[84:87], v[32:47]
    ds_read_b64_tr_b16 v[96:97], v104 offset:59392
    ds_read_b64_tr_b16 v[98:99], v104 offset:60416
    s_waitcnt vmcnt(9)
    s_waitcnt lgkmcnt(4)
    v_mfma_f32_32x32x16_bf16 v[16:31], v[240:243], v[88:91], v[16:31]
    ds_read_b64_tr_b16 v[100:101], v105 offset:59392
    ds_read_b64_tr_b16 v[102:103], v105 offset:60416
    s_add_u32 m0, s12, 122880
    s_add_u32 s9, s10, 122880
    buffer_load_dwordx4 v6, s[68:71], s9 offen lds
    s_waitcnt lgkmcnt(4)
    v_mfma_f32_32x32x16_bf16 v[32:47], v[240:243], v[92:95], v[32:47]
    ds_read_b64_tr_b16 v[80:81], v104 offset:61440
    ds_read_b64_tr_b16 v[82:83], v104 offset:62464
    s_waitcnt lgkmcnt(4)
    v_mfma_f32_32x32x16_bf16 v[16:31], v[244:247], v[96:99], v[16:31]
    ds_read_b64_tr_b16 v[84:85], v105 offset:61440
    ds_read_b64_tr_b16 v[86:87], v105 offset:62464
    s_waitcnt lgkmcnt(4)
    v_mfma_f32_32x32x16_bf16 v[32:47], v[244:247], v[100:103], v[32:47]
    ds_read_b64_tr_b16 v[88:89], v104 offset:63488
    ds_read_b64_tr_b16 v[90:91], v104 offset:64512
    s_waitcnt vmcnt(8)
    s_waitcnt lgkmcnt(4)
    v_mfma_f32_32x32x16_bf16 v[16:31], v[248:251], v[80:83], v[16:31]
    ds_read_b64_tr_b16 v[92:93], v105 offset:63488
    ds_read_b64_tr_b16 v[94:95], v105 offset:64512
    s_waitcnt vmcnt(0)
    s_barrier
    s_waitcnt lgkmcnt(4)
    v_mfma_f32_32x32x16_bf16 v[32:47], v[248:251], v[84:87], v[32:47]
    ds_read_b64_tr_b16 v[96:97], v106 offset:0
    ds_read_b64_tr_b16 v[98:99], v106 offset:1024
    v_mov_b32 v6, 0xbdd2d3e8
    s_waitcnt lgkmcnt(4)
    v_mfma_f32_32x32x16_bf16 v[16:31], v[252:255], v[88:91], v[16:31]
    ds_read_b64_tr_b16 v[100:101], v107 offset:0
    ds_read_b64_tr_b16 v[102:103], v107 offset:1024
    s_waitcnt lgkmcnt(4)
    v_mfma_f32_32x32x16_bf16 v[32:47], v[252:255], v[92:95], v[32:47]
    ds_read_b64_tr_b16 v[80:81], v106 offset:2048
    ds_read_b64_tr_b16 v[82:83], v106 offset:3072
    s_waitcnt lgkmcnt(4)
    v_mfma_f32_32x32x16_bf16 v[48:63], v[128:131], v[96:99], 0
    ds_read_b64_tr_b16 v[84:85], v107 offset:2048
    ds_read_b64_tr_b16 v[86:87], v107 offset:3072
    s_waitcnt lgkmcnt(4)
    v_mfma_f32_32x32x16_bf16 v[64:79], v[128:131], v[100:103], 0
    ds_read_b64_tr_b16 v[88:89], v106 offset:4096
    ds_read_b64_tr_b16 v[90:91], v106 offset:5120
    ds_read_b64 v[0:1], v7 offset:0
    s_waitcnt lgkmcnt(4)
    v_mfma_f32_32x32x16_bf16 v[48:63], v[132:135], v[80:83], v[48:63]
    ds_read_b64_tr_b16 v[92:93], v107 offset:4096
    ds_read_b64_tr_b16 v[94:95], v107 offset:5120
    s_waitcnt lgkmcnt(4)
    v_mfma_f32_32x32x16_bf16 v[64:79], v[132:135], v[84:87], v[64:79]
    ds_read_b64_tr_b16 v[96:97], v106 offset:6144
    ds_read_b64_tr_b16 v[98:99], v106 offset:7168
    s_add_u32 s14, s62, 8192
    buffer_load_dwordx4 v[128:131], v5, s[68:71], s14 offen offset:0
    s_barrier
    s_waitcnt lgkmcnt(4)
    v_mfma_f32_32x32x16_bf16 v[48:63], v[136:139], v[88:91], v[48:63]
    ds_read_b64_tr_b16 v[100:101], v107 offset:6144
    ds_read_b64_tr_b16 v[102:103], v107 offset:7168
    v_fma_f32 v16, -v0, v112, v16
    v_fma_f32 v17, -v0, v113, v17
    v_fma_f32 v18, -v0, v114, v18
    v_fma_f32 v19, -v0, v115, v19
    v_mul_f32 v16, v16, v1
    v_mul_f32 v17, v17, v1
    s_waitcnt lgkmcnt(4)
    v_mfma_f32_32x32x16_bf16 v[64:79], v[136:139], v[92:95], v[64:79]
    ds_read_b64_tr_b16 v[80:81], v106 offset:8192
    ds_read_b64_tr_b16 v[82:83], v106 offset:9216
    buffer_load_dwordx4 v[132:135], v5, s[68:71], s14 offen offset:1024
    v_mul_f32 v18, v18, v1
    v_mul_f32 v19, v19, v1
    v_mul_f32 v8, v16, v16
    v_mul_f32 v9, v17, v17
    v_mul_f32 v10, v18, v18
    v_mul_f32 v11, v19, v19
    s_waitcnt lgkmcnt(4)
    v_mfma_f32_32x32x16_bf16 v[48:63], v[140:143], v[96:99], v[48:63]
    ds_read_b64_tr_b16 v[84:85], v107 offset:8192
    ds_read_b64_tr_b16 v[86:87], v107 offset:9216
    s_add_u32 m0, s57, 0
    s_add_u32 s9, s62, 0
    buffer_load_dwordx4 v5, s[68:71], s9 offen offset:0 lds
    v_fmaak_f32 v8, v8, v6, 0xc0135761
    v_fmaak_f32 v9, v9, v6, 0xc0135761
    v_fmaak_f32 v10, v10, v6, 0xc0135761
    v_fmaak_f32 v11, v11, v6, 0xc0135761
    v_mul_f32 v8, v8, v16
    v_mul_f32 v9, v9, v17
    s_waitcnt lgkmcnt(4)
    v_mfma_f32_32x32x16_bf16 v[64:79], v[140:143], v[100:103], v[64:79]
    ds_read_b64_tr_b16 v[88:89], v106 offset:10240
    ds_read_b64_tr_b16 v[90:91], v106 offset:11264
    buffer_load_dwordx4 v[136:139], v5, s[68:71], s14 offen offset:2048
    v_mul_f32 v10, v10, v18
    v_mul_f32 v11, v11, v19
    v_exp_f32 v8, v8
    v_fma_f32 v24, -v0, v120, v24
    v_mul_f32 v16, v16, v1
    v_exp_f32 v9, v9
    s_waitcnt lgkmcnt(4)
    v_mfma_f32_32x32x16_bf16 v[48:63], v[144:147], v[80:83], v[48:63]
    ds_read_b64_tr_b16 v[92:93], v107 offset:10240
    ds_read_b64_tr_b16 v[94:95], v107 offset:11264
    v_fma_f32 v25, -v0, v121, v25
    v_mul_f32 v17, v17, v1
    v_exp_f32 v10, v10
    v_fma_f32 v26, -v0, v122, v26
    v_mul_f32 v18, v18, v1
    v_exp_f32 v11, v11
    s_waitcnt lgkmcnt(4)
    v_mfma_f32_32x32x16_bf16 v[64:79], v[144:147], v[84:87], v[64:79]
    ds_read_b64_tr_b16 v[96:97], v106 offset:12288
    ds_read_b64_tr_b16 v[98:99], v106 offset:13312
    s_add_u32 m0, s57, 0
    s_add_u32 s9, s62, 0
    buffer_load_dwordx4 v5, s[68:71], s9 offen offset:1024 lds
    buffer_load_dwordx4 v[140:143], v5, s[68:71], s14 offen offset:3072
    v_fma_f32 v27, -v0, v123, v27
    v_mul_f32 v19, v19, v1
    v_add_f32 v8, 1.0, v8
    v_add_f32 v9, 1.0, v9
    v_add_f32 v10, 1.0, v10
    v_add_f32 v11, 1.0, v11
    s_waitcnt lgkmcnt(4)
    v_mfma_f32_32x32x16_bf16 v[48:63], v[148:151], v[88:91], v[48:63]
    ds_read_b64_tr_b16 v[100:101], v107 offset:12288
    ds_read_b64_tr_b16 v[102:103], v107 offset:13312
    v_rcp_f32 v8, v8
    v_mul_f32 v24, v24, v16
    v_rcp_f32 v9, v9
    v_mul_f32 v25, v25, v17
    v_rcp_f32 v10, v10
    v_mul_f32 v26, v26, v18
    s_waitcnt lgkmcnt(4)
    v_mfma_f32_32x32x16_bf16 v[64:79], v[148:151], v[92:95], v[64:79]
    ds_read_b64_tr_b16 v[80:81], v106 offset:14336
    ds_read_b64_tr_b16 v[82:83], v106 offset:15360
    s_add_u32 s14, s62, 12288
    buffer_load_dwordx4 v[144:147], v5, s[68:71], s14 offen offset:0
    v_rcp_f32 v11, v11
    v_mul_f32 v27, v27, v19
    v_mul_f32 v24, v24, v8
    v_mul_f32 v25, v25, v9
    v_mul_f32 v26, v26, v10
    v_mul_f32 v27, v27, v11
    s_waitcnt lgkmcnt(4)
    v_mfma_f32_32x32x16_bf16 v[48:63], v[152:155], v[96:99], v[48:63]
    ds_read_b64_tr_b16 v[84:85], v107 offset:14336
    ds_read_b64_tr_b16 v[86:87], v107 offset:15360
    s_add_u32 m0, s57, 0
    s_add_u32 s9, s62, 0
    buffer_load_dwordx4 v5, s[68:71], s9 offen offset:2048 lds
    v_cvt_pk_bf16_f32 v12, v24, v25
    v_cvt_pk_bf16_f32 v13, v26, v27
    v_fma_f32 v20, -v0, v116, v20
    v_fma_f32 v21, -v0, v117, v21
    v_fma_f32 v22, -v0, v118, v22
    v_fma_f32 v23, -v0, v119, v23
    s_waitcnt lgkmcnt(4)
    v_mfma_f32_32x32x16_bf16 v[64:79], v[152:155], v[100:103], v[64:79]
    ds_read_b64_tr_b16 v[88:89], v106 offset:16384
    ds_read_b64_tr_b16 v[90:91], v106 offset:17408
    buffer_load_dwordx4 v[148:151], v5, s[68:71], s14 offen offset:1024
    v_mul_f32 v20, v20, v1
    v_mul_f32 v21, v21, v1
    v_mul_f32 v22, v22, v1
    v_mul_f32 v23, v23, v1
    v_mul_f32 v8, v20, v20
    v_mul_f32 v9, v21, v21
    s_waitcnt lgkmcnt(4)
    v_mfma_f32_32x32x16_bf16 v[48:63], v[156:159], v[80:83], v[48:63]
    ds_read_b64_tr_b16 v[92:93], v106 offset:18432
    ds_read_b64_tr_b16 v[94:95], v106 offset:19456
    v_mul_f32 v10, v22, v22
    v_mul_f32 v11, v23, v23
    v_fmaak_f32 v8, v8, v6, 0xc0135761
    v_fmaak_f32 v9, v9, v6, 0xc0135761
    v_fmaak_f32 v10, v10, v6, 0xc0135761
    v_fmaak_f32 v11, v11, v6, 0xc0135761
    s_waitcnt lgkmcnt(4)
    v_mfma_f32_32x32x16_bf16 v[64:79], v[156:159], v[84:87], v[64:79]
    ds_read_b64_tr_b16 v[96:97], v106 offset:20480
    ds_read_b64_tr_b16 v[98:99], v106 offset:21504
    s_add_u32 m0, s57, 0
    s_add_u32 s9, s62, 0
    buffer_load_dwordx4 v5, s[68:71], s9 offen offset:3072 lds
    buffer_load_dwordx4 v[152:155], v5, s[68:71], s14 offen offset:2048
    v_mul_f32 v8, v8, v20
    v_mul_f32 v9, v9, v21
    v_mul_f32 v10, v10, v22
    v_mul_f32 v11, v11, v23
    v_exp_f32 v8, v8
    v_fma_f32 v28, -v0, v124, v28
    s_waitcnt lgkmcnt(4)
    v_mfma_f32_32x32x16_bf16 v[48:63], v[160:163], v[88:91], v[48:63]
    ds_read_b64_tr_b16 v[100:101], v106 offset:22528
    ds_read_b64_tr_b16 v[102:103], v106 offset:23552
    v_mul_f32 v20, v20, v1
    v_exp_f32 v9, v9
    v_fma_f32 v29, -v0, v125, v29
    v_mul_f32 v21, v21, v1
    v_exp_f32 v10, v10
    v_fma_f32 v30, -v0, v126, v30
    s_waitcnt lgkmcnt(4)
    v_mfma_f32_32x32x16_bf16 v[48:63], v[164:167], v[92:95], v[48:63]
    ds_read_b64_tr_b16 v[80:81], v106 offset:24576
    ds_read_b64_tr_b16 v[82:83], v106 offset:25600
    buffer_load_dwordx4 v[156:159], v5, s[68:71], s14 offen offset:3072
    v_mul_f32 v22, v22, v1
    v_exp_f32 v11, v11
    v_fma_f32 v31, -v0, v127, v31
    v_mul_f32 v23, v23, v1
    ds_read_b64 v[0:1], v7 offset:256
    v_add_f32 v8, 1.0, v8
    v_add_f32 v9, 1.0, v9
    s_waitcnt lgkmcnt(4)
    v_mfma_f32_32x32x16_bf16 v[48:63], v[168:171], v[96:99], v[48:63]
    ds_read_b64_tr_b16 v[84:85], v106 offset:26624
    ds_read_b64_tr_b16 v[86:87], v106 offset:27648
    s_add_u32 m0, s57, 4096
    s_add_u32 s9, s62, 4096
    buffer_load_dwordx4 v5, s[68:71], s9 offen offset:0 lds
    v_add_f32 v10, 1.0, v10
    v_add_f32 v11, 1.0, v11
    v_rcp_f32 v8, v8
    v_mul_f32 v28, v28, v20
    v_rcp_f32 v9, v9
    v_mul_f32 v29, v29, v21
    s_waitcnt lgkmcnt(4)
    v_mfma_f32_32x32x16_bf16 v[48:63], v[172:175], v[100:103], v[48:63]
    ds_read_b64_tr_b16 v[88:89], v106 offset:28672
    ds_read_b64_tr_b16 v[90:91], v106 offset:29696
    v_rcp_f32 v10, v10
    v_mul_f32 v30, v30, v22
    v_rcp_f32 v11, v11
    v_mul_f32 v31, v31, v23
    v_mul_f32 v28, v28, v8
    v_mul_f32 v29, v29, v9
    s_waitcnt lgkmcnt(4)
    v_mfma_f32_32x32x16_bf16 v[48:63], v[176:179], v[80:83], v[48:63]
    ds_read_b64_tr_b16 v[92:93], v106 offset:30720
    ds_read_b64_tr_b16 v[94:95], v106 offset:31744
    v_mul_f32 v30, v30, v10
    v_mul_f32 v31, v31, v11
    v_cvt_pk_bf16_f32 v14, v28, v29
    v_cvt_pk_bf16_f32 v15, v30, v31
    s_nop 0
    v_permlane32_swap_b32 v12, v14
    v_permlane32_swap_b32 v13, v15
    s_waitcnt lgkmcnt(4)
    v_mfma_f32_32x32x16_bf16 v[48:63], v[180:183], v[84:87], v[48:63]
    ds_read_b64_tr_b16 v[96:97], v106 offset:32768
    ds_read_b64_tr_b16 v[98:99], v106 offset:33792
    s_add_u32 m0, s57, 4096
    s_add_u32 s9, s62, 4096
    buffer_load_dwordx4 v5, s[68:71], s9 offen offset:1024 lds
    s_add_u32 s9, s59, 0
    buffer_store_dwordx4 v[12:15], v2, s[68:71], s9 offen sc1
    v_fma_f32 v32, -v0, v112, v32
    v_fma_f32 v33, -v0, v113, v33
    v_fma_f32 v34, -v0, v114, v34
    v_fma_f32 v35, -v0, v115, v35
    v_mul_f32 v32, v32, v1
    s_waitcnt lgkmcnt(4)
    v_mfma_f32_32x32x16_bf16 v[48:63], v[184:187], v[88:91], v[48:63]
    ds_read_b64_tr_b16 v[100:101], v106 offset:34816
    ds_read_b64_tr_b16 v[102:103], v106 offset:35840
    v_mul_f32 v33, v33, v1
    v_mul_f32 v34, v34, v1
    v_mul_f32 v35, v35, v1
    v_mul_f32 v8, v32, v32
    v_mul_f32 v9, v33, v33
    v_mul_f32 v10, v34, v34
    s_waitcnt lgkmcnt(4)
    v_mfma_f32_32x32x16_bf16 v[48:63], v[188:191], v[92:95], v[48:63]
    ds_read_b64_tr_b16 v[80:81], v106 offset:36864
    ds_read_b64_tr_b16 v[82:83], v106 offset:37888
    v_mul_f32 v11, v35, v35
    v_fmaak_f32 v8, v8, v6, 0xc0135761
    v_fmaak_f32 v9, v9, v6, 0xc0135761
    v_fmaak_f32 v10, v10, v6, 0xc0135761
    v_fmaak_f32 v11, v11, v6, 0xc0135761
    v_mul_f32 v8, v8, v32
    s_waitcnt lgkmcnt(4)
    v_mfma_f32_32x32x16_bf16 v[48:63], v[192:195], v[96:99], v[48:63]
    ds_read_b64_tr_b16 v[84:85], v106 offset:38912
    ds_read_b64_tr_b16 v[86:87], v106 offset:39936
    s_add_u32 m0, s57, 4096
    s_add_u32 s9, s62, 4096
    buffer_load_dwordx4 v5, s[68:71], s9 offen offset:2048 lds
    v_mul_f32 v9, v9, v33
    v_mul_f32 v10, v10, v34
    v_mul_f32 v11, v11, v35
    v_exp_f32 v8, v8
    v_fma_f32 v40, -v0, v120, v40
    v_mul_f32 v32, v32, v1
    s_waitcnt lgkmcnt(4)
    v_mfma_f32_32x32x16_bf16 v[48:63], v[196:199], v[100:103], v[48:63]
    ds_read_b64_tr_b16 v[88:89], v106 offset:40960
    ds_read_b64_tr_b16 v[90:91], v106 offset:41984
    v_exp_f32 v9, v9
    v_fma_f32 v41, -v0, v121, v41
    v_mul_f32 v33, v33, v1
    v_exp_f32 v10, v10
    v_fma_f32 v42, -v0, v122, v42
    v_mul_f32 v34, v34, v1
    s_waitcnt lgkmcnt(4)
    v_mfma_f32_32x32x16_bf16 v[48:63], v[200:203], v[80:83], v[48:63]
    ds_read_b64_tr_b16 v[92:93], v106 offset:43008
    ds_read_b64_tr_b16 v[94:95], v106 offset:44032
    v_exp_f32 v11, v11
    v_fma_f32 v43, -v0, v123, v43
    v_mul_f32 v35, v35, v1
    v_add_f32 v8, 1.0, v8
    v_add_f32 v9, 1.0, v9
    v_add_f32 v10, 1.0, v10
    s_waitcnt lgkmcnt(4)
    v_mfma_f32_32x32x16_bf16 v[48:63], v[204:207], v[84:87], v[48:63]
    ds_read_b64_tr_b16 v[96:97], v106 offset:45056
    ds_read_b64_tr_b16 v[98:99], v106 offset:46080
    s_add_u32 m0, s57, 4096
    s_add_u32 s9, s62, 4096
    buffer_load_dwordx4 v5, s[68:71], s9 offen offset:3072 lds
    v_add_f32 v11, 1.0, v11
    v_rcp_f32 v8, v8
    v_mul_f32 v40, v40, v32
    v_rcp_f32 v9, v9
    v_mul_f32 v41, v41, v33
    v_rcp_f32 v10, v10
    s_waitcnt lgkmcnt(4)
    v_mfma_f32_32x32x16_bf16 v[48:63], v[208:211], v[88:91], v[48:63]
    ds_read_b64_tr_b16 v[100:101], v106 offset:47104
    ds_read_b64_tr_b16 v[102:103], v106 offset:48128
    v_mul_f32 v42, v42, v34
    v_rcp_f32 v11, v11
    v_mul_f32 v43, v43, v35
    v_mul_f32 v40, v40, v8
    v_mul_f32 v41, v41, v9
    v_mul_f32 v42, v42, v10
    s_waitcnt lgkmcnt(4)
    v_mfma_f32_32x32x16_bf16 v[48:63], v[212:215], v[92:95], v[48:63]
    ds_read_b64_tr_b16 v[80:81], v106 offset:49152
    ds_read_b64_tr_b16 v[82:83], v106 offset:50176
    v_mul_f32 v43, v43, v11
    v_cvt_pk_bf16_f32 v12, v40, v41
    v_cvt_pk_bf16_f32 v13, v42, v43
    v_fma_f32 v36, -v0, v116, v36
    v_fma_f32 v37, -v0, v117, v37
    v_fma_f32 v38, -v0, v118, v38
    s_waitcnt lgkmcnt(4)
    v_mfma_f32_32x32x16_bf16 v[48:63], v[216:219], v[96:99], v[48:63]
    ds_read_b64_tr_b16 v[84:85], v106 offset:51200
    ds_read_b64_tr_b16 v[86:87], v106 offset:52224
    v_fma_f32 v39, -v0, v119, v39
    v_mul_f32 v36, v36, v1
    v_mul_f32 v37, v37, v1
    v_mul_f32 v38, v38, v1
    v_mul_f32 v39, v39, v1
    v_mul_f32 v8, v36, v36
    s_waitcnt lgkmcnt(4)
    v_mfma_f32_32x32x16_bf16 v[48:63], v[220:223], v[100:103], v[48:63]
    ds_read_b64_tr_b16 v[88:89], v106 offset:53248
    ds_read_b64_tr_b16 v[90:91], v106 offset:54272
    v_mul_f32 v9, v37, v37
    v_mul_f32 v10, v38, v38
    v_mul_f32 v11, v39, v39
    v_fmaak_f32 v8, v8, v6, 0xc0135761
    v_fmaak_f32 v9, v9, v6, 0xc0135761
    v_fmaak_f32 v10, v10, v6, 0xc0135761
    s_waitcnt lgkmcnt(4)
    v_mfma_f32_32x32x16_bf16 v[48:63], v[224:227], v[80:83], v[48:63]
    ds_read_b64_tr_b16 v[92:93], v106 offset:55296
    ds_read_b64_tr_b16 v[94:95], v106 offset:56320
    v_fmaak_f32 v11, v11, v6, 0xc0135761
    v_mul_f32 v8, v8, v36
    v_mul_f32 v9, v9, v37
    v_mul_f32 v10, v10, v38
    v_mul_f32 v11, v11, v39
    v_exp_f32 v8, v8
    s_waitcnt lgkmcnt(4)
    v_mfma_f32_32x32x16_bf16 v[48:63], v[228:231], v[84:87], v[48:63]
    ds_read_b64_tr_b16 v[96:97], v106 offset:57344
    ds_read_b64_tr_b16 v[98:99], v106 offset:58368
    v_fma_f32 v44, -v0, v124, v44
    v_mul_f32 v36, v36, v1
    v_exp_f32 v9, v9
    v_fma_f32 v45, -v0, v125, v45
    v_mul_f32 v37, v37, v1
    v_exp_f32 v10, v10
    s_waitcnt lgkmcnt(4)
    v_mfma_f32_32x32x16_bf16 v[48:63], v[232:235], v[88:91], v[48:63]
    ds_read_b64_tr_b16 v[100:101], v106 offset:59392
    ds_read_b64_tr_b16 v[102:103], v106 offset:60416
    v_fma_f32 v46, -v0, v126, v46
    v_mul_f32 v38, v38, v1
    v_exp_f32 v11, v11
    v_fma_f32 v47, -v0, v127, v47
    v_mul_f32 v39, v39, v1
    v_add_f32 v8, 1.0, v8
    s_waitcnt lgkmcnt(4)
    v_mfma_f32_32x32x16_bf16 v[48:63], v[236:239], v[92:95], v[48:63]
    ds_read_b64_tr_b16 v[80:81], v106 offset:61440
    ds_read_b64_tr_b16 v[82:83], v106 offset:62464
    v_add_f32 v9, 1.0, v9
    v_add_f32 v10, 1.0, v10
    v_add_f32 v11, 1.0, v11
    v_rcp_f32 v8, v8
    v_mul_f32 v44, v44, v36
    v_rcp_f32 v9, v9
    s_waitcnt lgkmcnt(4)
    v_mfma_f32_32x32x16_bf16 v[48:63], v[240:243], v[96:99], v[48:63]
    ds_read_b64_tr_b16 v[84:85], v106 offset:63488
    ds_read_b64_tr_b16 v[86:87], v106 offset:64512
    v_mul_f32 v45, v45, v37
    v_rcp_f32 v10, v10
    v_mul_f32 v46, v46, v38
    v_rcp_f32 v11, v11
    v_mul_f32 v47, v47, v39
    v_mul_f32 v44, v44, v8
    s_waitcnt lgkmcnt(4)
    v_mfma_f32_32x32x16_bf16 v[48:63], v[244:247], v[100:103], v[48:63]
    ds_read_b64_tr_b16 v[88:89], v107 offset:16384
    ds_read_b64_tr_b16 v[90:91], v107 offset:17408
    v_mul_f32 v45, v45, v9
    v_mul_f32 v46, v46, v10
    v_mul_f32 v47, v47, v11
    v_cvt_pk_bf16_f32 v14, v44, v45
    v_cvt_pk_bf16_f32 v15, v46, v47
    s_nop 0
    v_permlane32_swap_b32 v12, v14
    s_waitcnt lgkmcnt(4)
    v_mfma_f32_32x32x16_bf16 v[48:63], v[248:251], v[80:83], v[48:63]
    ds_read_b64_tr_b16 v[92:93], v107 offset:18432
    ds_read_b64_tr_b16 v[94:95], v107 offset:19456
    v_permlane32_swap_b32 v13, v15
    s_add_u32 s9, s59, 114688
    buffer_store_dwordx4 v[12:15], v2, s[68:71], s9 offen sc1
    s_waitcnt lgkmcnt(4)
    v_mfma_f32_32x32x16_bf16 v[48:63], v[252:255], v[84:87], v[48:63]
    ds_read_b64_tr_b16 v[96:97], v107 offset:20480
    ds_read_b64_tr_b16 v[98:99], v107 offset:21504
    s_waitcnt lgkmcnt(4)
    v_mfma_f32_32x32x16_bf16 v[64:79], v[160:163], v[88:91], v[64:79]
    ds_read_b64_tr_b16 v[100:101], v107 offset:22528
    ds_read_b64_tr_b16 v[102:103], v107 offset:23552
    s_waitcnt lgkmcnt(4)
    v_mfma_f32_32x32x16_bf16 v[64:79], v[164:167], v[92:95], v[64:79]
    ds_read_b64_tr_b16 v[80:81], v107 offset:24576
    ds_read_b64_tr_b16 v[82:83], v107 offset:25600
    s_add_u32 s14, s62, 16384
    buffer_load_dwordx4 v[160:163], v5, s[68:71], s14 offen offset:0
    s_waitcnt lgkmcnt(4)
    v_mfma_f32_32x32x16_bf16 v[64:79], v[168:171], v[96:99], v[64:79]
    ds_read_b64_tr_b16 v[84:85], v107 offset:26624
    ds_read_b64_tr_b16 v[86:87], v107 offset:27648
    buffer_load_dwordx4 v[164:167], v5, s[68:71], s14 offen offset:1024
    s_waitcnt lgkmcnt(4)
    v_mfma_f32_32x32x16_bf16 v[64:79], v[172:175], v[100:103], v[64:79]
    ds_read_b64_tr_b16 v[88:89], v107 offset:28672
    ds_read_b64_tr_b16 v[90:91], v107 offset:29696
    buffer_load_dwordx4 v[168:171], v5, s[68:71], s14 offen offset:2048
    s_barrier
    s_waitcnt lgkmcnt(4)
    v_mfma_f32_32x32x16_bf16 v[64:79], v[176:179], v[80:83], v[64:79]
    ds_read_b64_tr_b16 v[92:93], v107 offset:30720
    ds_read_b64_tr_b16 v[94:95], v107 offset:31744
    buffer_load_dwordx4 v[172:175], v5, s[68:71], s14 offen offset:3072
    ds_read_b64 v[0:1], v7 offset:512
    s_waitcnt lgkmcnt(4)
    v_mfma_f32_32x32x16_bf16 v[64:79], v[180:183], v[84:87], v[64:79]
    ds_read_b64_tr_b16 v[96:97], v107 offset:32768
    ds_read_b64_tr_b16 v[98:99], v107 offset:33792
    s_add_u32 s14, s62, 20480
    buffer_load_dwordx4 v[176:179], v5, s[68:71], s14 offen offset:0
    s_waitcnt vmcnt(5)
    s_mov_b64 exec, 1
    v_mov_b32 v108, 1
    ds_add_rtn_u32 v109, v7, v108 offset:1024
    s_waitcnt lgkmcnt(0)
    v_readfirstlane_b32 s9, v109
    s_nop 1
    s_cmp_lg_u32 s9, 6
    s_nop 1
    s_cbranch_scc1 KB_S0
    s_mov_b64 exec, 0xffff
    v_mov_b32 v108, 1
    v_lshlrev_b32 v109, 7, v4
    buffer_store_dword v108, v109, s[68:71], s66 offen offset:0 sc1
    s_nop 1
KB_S0:
    s_mov_b64 exec, -1
    s_waitcnt lgkmcnt(4)
    v_mfma_f32_32x32x16_bf16 v[64:79], v[184:187], v[88:91], v[64:79]
    ds_read_b64_tr_b16 v[100:101], v107 offset:34816
    ds_read_b64_tr_b16 v[102:103], v107 offset:35840
    buffer_load_dwordx4 v[180:183], v5, s[68:71], s14 offen offset:1024
    s_waitcnt lgkmcnt(4)
    v_mfma_f32_32x32x16_bf16 v[64:79], v[188:191], v[92:95], v[64:79]
    ds_read_b64_tr_b16 v[80:81], v107 offset:36864
    ds_read_b64_tr_b16 v[82:83], v107 offset:37888
    buffer_load_dwordx4 v[184:187], v5, s[68:71], s14 offen offset:2048
    v_fma_f32 v48, -v0, v112, v48
    v_fma_f32 v49, -v0, v113, v49
    v_fma_f32 v50, -v0, v114, v50
    v_fma_f32 v51, -v0, v115, v51
    v_mul_f32 v48, v48, v1
    v_mul_f32 v49, v49, v1
    s_waitcnt lgkmcnt(4)
    v_mfma_f32_32x32x16_bf16 v[64:79], v[192:195], v[96:99], v[64:79]
    ds_read_b64_tr_b16 v[84:85], v107 offset:38912
    ds_read_b64_tr_b16 v[86:87], v107 offset:39936
    buffer_load_dwordx4 v[188:191], v5, s[68:71], s14 offen offset:3072
    v_mul_f32 v50, v50, v1
    v_mul_f32 v51, v51, v1
    v_mul_f32 v8, v48, v48
    v_mul_f32 v9, v49, v49
    v_mul_f32 v10, v50, v50
    v_mul_f32 v11, v51, v51
    s_waitcnt lgkmcnt(4)
    v_mfma_f32_32x32x16_bf16 v[64:79], v[196:199], v[100:103], v[64:79]
    ds_read_b64_tr_b16 v[88:89], v107 offset:40960
    ds_read_b64_tr_b16 v[90:91], v107 offset:41984
    s_add_u32 s14, s62, 24576
    buffer_load_dwordx4 v[192:195], v5, s[68:71], s14 offen offset:0
    v_fmaak_f32 v8, v8, v6, 0xc0135761
    v_fmaak_f32 v9, v9, v6, 0xc0135761
    v_fmaak_f32 v10, v10, v6, 0xc0135761
    v_fmaak_f32 v11, v11, v6, 0xc0135761
    v_mul_f32 v8, v8, v48
    v_mul_f32 v9, v9, v49
    s_waitcnt lgkmcnt(4)
    v_mfma_f32_32x32x16_bf16 v[64:79], v[200:203], v[80:83], v[64:79]
    ds_read_b64_tr_b16 v[92:93], v107 offset:43008
    ds_read_b64_tr_b16 v[94:95], v107 offset:44032
    buffer_load_dwordx4 v[196:199], v5, s[68:71], s14 offen offset:1024
    v_mul_f32 v10, v10, v50
    v_mul_f32 v11, v11, v51
    v_exp_f32 v8, v8
    v_fma_f32 v56, -v0, v120, v56
    v_mul_f32 v48, v48, v1
    v_exp_f32 v9, v9
    s_waitcnt lgkmcnt(4)
    v_mfma_f32_32x32x16_bf16 v[64:79], v[204:207], v[84:87], v[64:79]
    ds_read_b64_tr_b16 v[96:97], v107 offset:45056
    ds_read_b64_tr_b16 v[98:99], v107 offset:46080
    buffer_load_dwordx4 v[200:203], v5, s[68:71], s14 offen offset:2048
    v_fma_f32 v57, -v0, v121, v57
    v_mul_f32 v49, v49, v1
    v_exp_f32 v10, v10
    v_fma_f32 v58, -v0, v122, v58
    v_mul_f32 v50, v50, v1
    v_exp_f32 v11, v11
    s_waitcnt lgkmcnt(4)
    v_mfma_f32_32x32x16_bf16 v[64:79], v[208:211], v[88:91], v[64:79]
    ds_read_b64_tr_b16 v[100:101], v107 offset:47104
    ds_read_b64_tr_b16 v[102:103], v107 offset:48128
    buffer_load_dwordx4 v[204:207], v5, s[68:71], s14 offen offset:3072
    v_fma_f32 v59, -v0, v123, v59
    v_mul_f32 v51, v51, v1
    v_add_f32 v8, 1.0, v8
    v_add_f32 v9, 1.0, v9
    v_add_f32 v10, 1.0, v10
    v_add_f32 v11, 1.0, v11
    s_waitcnt lgkmcnt(4)
    v_mfma_f32_32x32x16_bf16 v[64:79], v[212:215], v[92:95], v[64:79]
    ds_read_b64_tr_b16 v[80:81], v107 offset:49152
    ds_read_b64_tr_b16 v[82:83], v107 offset:50176
    v_rcp_f32 v8, v8
    v_mul_f32 v56, v56, v48
    v_rcp_f32 v9, v9
    v_mul_f32 v57, v57, v49
    v_rcp_f32 v10, v10
    v_mul_f32 v58, v58, v50
    s_waitcnt lgkmcnt(4)
    v_mfma_f32_32x32x16_bf16 v[64:79], v[216:219], v[96:99], v[64:79]
    ds_read_b64_tr_b16 v[84:85], v107 offset:51200
    ds_read_b64_tr_b16 v[86:87], v107 offset:52224
    v_rcp_f32 v11, v11
    v_mul_f32 v59, v59, v51
    v_mul_f32 v56, v56, v8
    v_mul_f32 v57, v57, v9
    v_mul_f32 v58, v58, v10
    v_mul_f32 v59, v59, v11
    s_waitcnt lgkmcnt(4)
    v_mfma_f32_32x32x16_bf16 v[64:79], v[220:223], v[100:103], v[64:79]
    ds_read_b64_tr_b16 v[88:89], v107 offset:53248
    ds_read_b64_tr_b16 v[90:91], v107 offset:54272
    v_cvt_pk_bf16_f32 v12, v56, v57
    v_cvt_pk_bf16_f32 v13, v58, v59
    v_fma_f32 v52, -v0, v116, v52
    v_fma_f32 v53, -v0, v117, v53
    v_fma_f32 v54, -v0, v118, v54
    v_fma_f32 v55, -v0, v119, v55
    s_waitcnt lgkmcnt(4)
    v_mfma_f32_32x32x16_bf16 v[64:79], v[224:227], v[80:83], v[64:79]
    ds_read_b64_tr_b16 v[92:93], v107 offset:55296
    ds_read_b64_tr_b16 v[94:95], v107 offset:56320
    v_mul_f32 v52, v52, v1
    v_mul_f32 v53, v53, v1
    v_mul_f32 v54, v54, v1
    v_mul_f32 v55, v55, v1
    v_mul_f32 v8, v52, v52
    v_mul_f32 v9, v53, v53
    s_waitcnt lgkmcnt(4)
    v_mfma_f32_32x32x16_bf16 v[64:79], v[228:231], v[84:87], v[64:79]
    ds_read_b64_tr_b16 v[96:97], v107 offset:57344
    ds_read_b64_tr_b16 v[98:99], v107 offset:58368
    v_mul_f32 v10, v54, v54
    v_mul_f32 v11, v55, v55
    v_fmaak_f32 v8, v8, v6, 0xc0135761
    v_fmaak_f32 v9, v9, v6, 0xc0135761
    v_fmaak_f32 v10, v10, v6, 0xc0135761
    v_fmaak_f32 v11, v11, v6, 0xc0135761
    s_waitcnt lgkmcnt(4)
    v_mfma_f32_32x32x16_bf16 v[64:79], v[232:235], v[88:91], v[64:79]
    ds_read_b64_tr_b16 v[100:101], v107 offset:59392
    ds_read_b64_tr_b16 v[102:103], v107 offset:60416
    v_mul_f32 v8, v8, v52
    v_mul_f32 v9, v9, v53
    v_mul_f32 v10, v10, v54
    v_mul_f32 v11, v11, v55
    v_exp_f32 v8, v8
    v_fma_f32 v60, -v0, v124, v60
    s_waitcnt lgkmcnt(4)
    v_mfma_f32_32x32x16_bf16 v[64:79], v[236:239], v[92:95], v[64:79]
    ds_read_b64_tr_b16 v[80:81], v107 offset:61440
    ds_read_b64_tr_b16 v[82:83], v107 offset:62464
    v_mul_f32 v52, v52, v1
    v_exp_f32 v9, v9
    v_fma_f32 v61, -v0, v125, v61
    v_mul_f32 v53, v53, v1
    v_exp_f32 v10, v10
    v_fma_f32 v62, -v0, v126, v62
    s_waitcnt lgkmcnt(4)
    v_mfma_f32_32x32x16_bf16 v[64:79], v[240:243], v[96:99], v[64:79]
    ds_read_b64_tr_b16 v[84:85], v107 offset:63488
    ds_read_b64_tr_b16 v[86:87], v107 offset:64512
    v_mul_f32 v54, v54, v1
    v_exp_f32 v11, v11
    v_fma_f32 v63, -v0, v127, v63
    v_mul_f32 v55, v55, v1
    v_add_f32 v8, 1.0, v8
    v_add_f32 v9, 1.0, v9
    s_waitcnt lgkmcnt(4)
    v_mfma_f32_32x32x16_bf16 v[64:79], v[244:247], v[100:103], v[64:79]
    v_add_f32 v10, 1.0, v10
    v_add_f32 v11, 1.0, v11
    v_rcp_f32 v8, v8
    v_mul_f32 v60, v60, v52
    v_rcp_f32 v9, v9
    v_mul_f32 v61, v61, v53
    s_waitcnt lgkmcnt(2)
    v_mfma_f32_32x32x16_bf16 v[64:79], v[248:251], v[80:83], v[64:79]
    v_rcp_f32 v10, v10
    v_mul_f32 v62, v62, v54
    v_rcp_f32 v11, v11
    v_mul_f32 v63, v63, v55
    v_mul_f32 v60, v60, v8
    v_mul_f32 v61, v61, v9
    s_waitcnt lgkmcnt(0)
    v_mfma_f32_32x32x16_bf16 v[64:79], v[252:255], v[84:87], v[64:79]
    v_mul_f32 v62, v62, v10
    v_mul_f32 v63, v63, v11
    v_cvt_pk_bf16_f32 v14, v60, v61
    v_cvt_pk_bf16_f32 v15, v62, v63
    s_nop 0
    v_permlane32_swap_b32 v12, v14
    v_permlane32_swap_b32 v13, v15
    s_waitcnt lgkmcnt(0)
    s_add_u32 s9, s59, 229376
    buffer_store_dwordx4 v[12:15], v2, s[68:71], s9 offen sc1
    s_barrier
    ds_read_b64 v[0:1], v7 offset:768
    s_waitcnt lgkmcnt(0)
    v_fma_f32 v64, -v0, v112, v64
    v_fma_f32 v65, -v0, v113, v65
    v_fma_f32 v66, -v0, v114, v66
    v_fma_f32 v67, -v0, v115, v67
    v_mul_f32 v64, v64, v1
    v_mul_f32 v65, v65, v1
    v_mul_f32 v66, v66, v1
    v_mul_f32 v67, v67, v1
    v_mul_f32 v8, v64, v64
    v_mul_f32 v9, v65, v65
    v_mul_f32 v10, v66, v66
    v_mul_f32 v11, v67, v67
    v_fmaak_f32 v8, v8, v6, 0xc0135761
    v_fmaak_f32 v9, v9, v6, 0xc0135761
    v_fmaak_f32 v10, v10, v6, 0xc0135761
    v_fmaak_f32 v11, v11, v6, 0xc0135761
    v_mul_f32 v8, v8, v64
    v_mul_f32 v9, v9, v65
    v_mul_f32 v10, v10, v66
    v_mul_f32 v11, v11, v67
    v_exp_f32 v8, v8
    v_fma_f32 v72, -v0, v120, v72
    v_mul_f32 v64, v64, v1
    v_exp_f32 v9, v9
    v_fma_f32 v73, -v0, v121, v73
    v_mul_f32 v65, v65, v1
    v_exp_f32 v10, v10
    v_fma_f32 v74, -v0, v122, v74
    v_mul_f32 v66, v66, v1
    v_exp_f32 v11, v11
    v_fma_f32 v75, -v0, v123, v75
    v_mul_f32 v67, v67, v1
    v_add_f32 v8, 1.0, v8
    v_add_f32 v9, 1.0, v9
    v_add_f32 v10, 1.0, v10
    v_add_f32 v11, 1.0, v11
    v_rcp_f32 v8, v8
    v_mul_f32 v72, v72, v64
    v_rcp_f32 v9, v9
    v_mul_f32 v73, v73, v65
    v_rcp_f32 v10, v10
    v_mul_f32 v74, v74, v66
    v_rcp_f32 v11, v11
    v_mul_f32 v75, v75, v67
    v_mul_f32 v72, v72, v8
    v_mul_f32 v73, v73, v9
    v_mul_f32 v74, v74, v10
    v_mul_f32 v75, v75, v11
    v_cvt_pk_bf16_f32 v12, v72, v73
    v_cvt_pk_bf16_f32 v13, v74, v75
    v_fma_f32 v68, -v0, v116, v68
    v_fma_f32 v69, -v0, v117, v69
    v_fma_f32 v70, -v0, v118, v70
    v_fma_f32 v71, -v0, v119, v71
    v_mul_f32 v68, v68, v1
    v_mul_f32 v69, v69, v1
    v_mul_f32 v70, v70, v1
    v_mul_f32 v71, v71, v1
    v_mul_f32 v8, v68, v68
    v_mul_f32 v9, v69, v69
    v_mul_f32 v10, v70, v70
    v_mul_f32 v11, v71, v71
    v_fmaak_f32 v8, v8, v6, 0xc0135761
    v_fmaak_f32 v9, v9, v6, 0xc0135761
    v_fmaak_f32 v10, v10, v6, 0xc0135761
    v_fmaak_f32 v11, v11, v6, 0xc0135761
    v_mul_f32 v8, v8, v68
    v_mul_f32 v9, v9, v69
    v_mul_f32 v10, v10, v70
    v_mul_f32 v11, v11, v71
    v_exp_f32 v8, v8
    v_fma_f32 v76, -v0, v124, v76
    v_mul_f32 v68, v68, v1
    v_exp_f32 v9, v9
    v_fma_f32 v77, -v0, v125, v77
    v_mul_f32 v69, v69, v1
    v_exp_f32 v10, v10
    v_fma_f32 v78, -v0, v126, v78
    v_mul_f32 v70, v70, v1
    v_exp_f32 v11, v11
    v_fma_f32 v79, -v0, v127, v79
    v_mul_f32 v71, v71, v1
    v_add_f32 v8, 1.0, v8
    v_add_f32 v9, 1.0, v9
    v_add_f32 v10, 1.0, v10
    v_add_f32 v11, 1.0, v11
    v_rcp_f32 v8, v8
    v_mul_f32 v76, v76, v68
    v_rcp_f32 v9, v9
    v_mul_f32 v77, v77, v69
    v_rcp_f32 v10, v10
    v_mul_f32 v78, v78, v70
    v_rcp_f32 v11, v11
    v_mul_f32 v79, v79, v71
    v_mul_f32 v76, v76, v8
    v_mul_f32 v77, v77, v9
    v_mul_f32 v78, v78, v10
    v_mul_f32 v79, v79, v11
    v_cvt_pk_bf16_f32 v14, v76, v77
    v_cvt_pk_bf16_f32 v15, v78, v79
    s_nop 0
    v_permlane32_swap_b32 v12, v14
    v_permlane32_swap_b32 v13, v15
    s_add_u32 s9, s59, 344064
    buffer_store_dwordx4 v[12:15], v2, s[68:71], s9 offen sc1
    s_nop 1
    s_branch KB_P2
KB_W7:
    s_add_u32 m0, s12, 0
    s_add_u32 s9, s10, 0
    buffer_load_dwordx4 v6, s[68:71], s9 offen lds
    s_add_u32 m0, s12, 8192
    s_add_u32 s9, s10, 8192
    buffer_load_dwordx4 v6, s[68:71], s9 offen lds
    s_barrier
    s_add_u32 m0, s12, 16384
    s_add_u32 s9, s10, 16384
    buffer_load_dwordx4 v6, s[68:71], s9 offen lds
    s_add_u32 m0, s12, 24576
    s_add_u32 s9, s10, 24576
    buffer_load_dwordx4 v6, s[68:71], s9 offen lds
    v_lshrrev_b32 v8, 2, v4
    v_and_b32 v9, 3, v4
    v_lshl_add_u32 v10, v3, 2, v8
    v_and_b32 v11, 2, v10
    v_lshlrev_b32 v12, 3, v9
    v_lshl_add_u32 v12, v10, 7, v12
    v_lshl_add_u32 v104, v11, 5, v12
    v_xor_b32 v105, 32, v104
    v_xor_b32 v106, 64, v104
    v_xor_b32 v107, 96, v104
    v_add_u32 v108, 0x10000, v104
    v_add_u32 v109, 0x10000, v105
    v_add_u32 v110, 0x10000, v106
    v_add_u32 v111, 0x10000, v107
    v_mov_b32 v112, 0x3f803f80
    v_mov_b32 v116, 0
    v_mov_b32 v113, 0x3f803f80
    v_mov_b32 v117, 0
    v_mov_b32 v114, 0x3f803f80
    v_mov_b32 v118, 0
    v_mov_b32 v115, 0x3f803f80
    v_mov_b32 v119, 0
    v_mov_b32 v13, 132096
    ds_write_b128 v13, v[116:119]
    ds_write_b128 v13, v[116:119] offset:16
    s_setprio 2
    s_waitcnt vmcnt(2) lgkmcnt(0)
    s_barrier
    ds_read_b64_tr_b16 v[80:81], v104 offset:0
    ds_read_b64_tr_b16 v[82:83], v104 offset:2048
    ds_read_b64_tr_b16 v[84:85], v105 offset:0
    ds_read_b64_tr_b16 v[86:87], v105 offset:2048
    ds_read_b64_tr_b16 v[88:89], v106 offset:0
    ds_read_b64_tr_b16 v[90:91], v106 offset:2048
    s_waitcnt lgkmcnt(4)
    v_mfma_f32_16x16x32_bf16 v[16:19], v[112:115], v[80:83], 0
    ds_read_b64_tr_b16 v[92:93], v107 offset:0
    ds_read_b64_tr_b16 v[94:95], v107 offset:2048
    v_mfma_f32_16x16x32_bf16 v[20:23], v[80:83], v[80:83], 0
    s_add_u32 m0, s12, 32768
    s_add_u32 s9, s10, 32768
    buffer_load_dwordx4 v6, s[68:71], s9 offen lds
    s_waitcnt lgkmcnt(4)
    v_mfma_f32_16x16x32_bf16 v[24:27], v[112:115], v[84:87], 0
    ds_read_b64_tr_b16 v[96:97], v104 offset:4096
    ds_read_b64_tr_b16 v[98:99], v104 offset:6144
    v_mfma_f32_16x16x32_bf16 v[28:31], v[84:87], v[84:87], 0
    s_mov_b32 s48, s38
    s_and_b32 s49, s39, 0xffff
    s_mov_b32 s50, 2097152
    s_mov_b32 s51, 0x00020000
    s_lshl_b32 s60, s4, 1
    s_lshr_b32 s9, s5, 4
    s_add_u32 s60, s60, s9
    s_bfe_u32 s58, s5, 0x10003
    s_and_b32 s61, s5, 7
    s_mul_i32 s62, s61, 56
    s_mul_i32 s9, s3, 7
    s_add_u32 s62, s62, s9
    s_lshl_b32 s62, s62, 12
    s_add_u32 s62, s62, 19922944
    s_lshl_b32 s63, s60, 3
    s_lshl_b32 s14, s58, 1
    s_add_u32 s63, s63, s14
    s_mul_i32 s63, s63, 57344
    s_add_u32 s63, s63, 11534336
    s_mul_i32 s9, s3, 7168
    s_add_u32 s63, s63, s9
    s_lshl_b32 s57, s3, 13
    s_lshl_b32 s66, s6, 11
    s_lshl_b32 s14, s7, 2
    s_add_u32 s66, s66, s14
    s_add_u32 s66, s66, 27262976
    s_lshl_b32 s67, s60, 4
    s_lshl_b32 s9, s58, 3
    s_add_u32 s67, s67, s9
    s_add_u32 s67, s67, s61
    s_lshl_b32 s67, s67, 7
    s_add_u32 s67, s67, 27262976
    v_mov_b32 v7, 131072
    v_cmp_eq_u32 s[52:53], 1, v9
    v_cmp_eq_u32 s[54:55], 2, v9
    v_cmp_eq_u32 s[44:45], 3, v9
    v_cmp_eq_u32 s[64:65], v8, v3
    s_waitcnt lgkmcnt(4)
    v_mfma_f32_16x16x32_bf16 v[32:35], v[112:115], v[88:91], 0
    ds_read_b64_tr_b16 v[100:101], v105 offset:4096
    ds_read_b64_tr_b16 v[102:103], v105 offset:6144
    v_mfma_f32_16x16x32_bf16 v[36:39], v[88:91], v[88:91], 0
    s_add_u32 m0, s12, 40960
    s_add_u32 s9, s10, 40960
    buffer_load_dwordx4 v6, s[68:71], s9 offen lds
    s_waitcnt lgkmcnt(4)
    v_mfma_f32_16x16x32_bf16 v[40:43], v[112:115], v[92:95], 0
    ds_read_b64_tr_b16 v[80:81], v106 offset:4096
    ds_read_b64_tr_b16 v[82:83], v106 offset:6144
    v_mfma_f32_16x16x32_bf16 v[44:47], v[92:95], v[92:95], 0
    s_waitcnt lgkmcnt(4)
    v_mfma_f32_16x16x32_bf16 v[16:19], v[112:115], v[96:99], v[16:19]
    ds_read_b64_tr_b16 v[84:85], v107 offset:4096
    ds_read_b64_tr_b16 v[86:87], v107 offset:6144
    v_mfma_f32_16x16x32_bf16 v[20:23], v[96:99], v[96:99], v[20:23]
    s_waitcnt lgkmcnt(4)
    v_mfma_f32_16x16x32_bf16 v[24:27], v[112:115], v[100:103], v[24:27]
    ds_read_b64_tr_b16 v[88:89], v104 offset:8192
    ds_read_b64_tr_b16 v[90:91], v104 offset:10240
    v_mfma_f32_16x16x32_bf16 v[28:31], v[100:103], v[100:103], v[28:31]
    s_add_u32 m0, s12, 49152
    s_add_u32 s9, s10, 49152
    buffer_load_dwordx4 v6, s[68:71], s9 offen lds
    s_waitcnt lgkmcnt(4)
    v_mfma_f32_16x16x32_bf16 v[32:35], v[112:115], v[80:83], v[32:35]
    ds_read_b64_tr_b16 v[92:93], v105 offset:8192
    ds_read_b64_tr_b16 v[94:95], v105 offset:10240
    v_mfma_f32_16x16x32_bf16 v[36:39], v[80:83], v[80:83], v[36:39]
    s_waitcnt lgkmcnt(4)
    v_mfma_f32_16x16x32_bf16 v[40:43], v[112:115], v[84:87], v[40:43]
    ds_read_b64_tr_b16 v[96:97], v106 offset:8192
    ds_read_b64_tr_b16 v[98:99], v106 offset:10240
    v_mfma_f32_16x16x32_bf16 v[44:47], v[84:87], v[84:87], v[44:47]
    s_waitcnt lgkmcnt(4)
    v_mfma_f32_16x16x32_bf16 v[16:19], v[112:115], v[88:91], v[16:19]
    ds_read_b64_tr_b16 v[100:101], v107 offset:8192
    ds_read_b64_tr_b16 v[102:103], v107 offset:10240
    v_mfma_f32_16x16x32_bf16 v[20:23], v[88:91], v[88:91], v[20:23]
    s_waitcnt lgkmcnt(4)
    v_mfma_f32_16x16x32_bf16 v[24:27], v[112:115], v[92:95], v[24:27]
    ds_read_b64_tr_b16 v[80:81], v104 offset:12288
    ds_read_b64_tr_b16 v[82:83], v104 offset:14336
    v_mfma_f32_16x16x32_bf16 v[28:31], v[92:95], v[92:95], v[28:31]
    s_add_u32 m0, s12, 57344
    s_add_u32 s9, s10, 57344
    buffer_load_dwordx4 v6, s[68:71], s9 offen lds
    s_waitcnt lgkmcnt(4)
    v_mfma_f32_16x16x32_bf16 v[32:35], v[112:115], v[96:99], v[32:35]
    ds_read_b64_tr_b16 v[84:85], v105 offset:12288
    ds_read_b64_tr_b16 v[86:87], v105 offset:14336
    v_mfma_f32_16x16x32_bf16 v[36:39], v[96:99], v[96:99], v[36:39]
    s_waitcnt lgkmcnt(4)
    v_mfma_f32_16x16x32_bf16 v[40:43], v[112:115], v[100:103], v[40:43]
    ds_read_b64_tr_b16 v[88:89], v106 offset:12288
    ds_read_b64_tr_b16 v[90:91], v106 offset:14336
    v_mfma_f32_16x16x32_bf16 v[44:47], v[100:103], v[100:103], v[44:47]
    s_waitcnt lgkmcnt(4)
    v_mfma_f32_16x16x32_bf16 v[16:19], v[112:115], v[80:83], v[16:19]
    ds_read_b64_tr_b16 v[92:93], v107 offset:12288
    ds_read_b64_tr_b16 v[94:95], v107 offset:14336
    v_mfma_f32_16x16x32_bf16 v[20:23], v[80:83], v[80:83], v[20:23]
    s_waitcnt vmcnt(4)
    s_barrier
    s_waitcnt lgkmcnt(4)
    v_mfma_f32_16x16x32_bf16 v[24:27], v[112:115], v[84:87], v[24:27]
    ds_read_b64_tr_b16 v[96:97], v104 offset:16384
    ds_read_b64_tr_b16 v[98:99], v104 offset:18432
    v_mfma_f32_16x16x32_bf16 v[28:31], v[84:87], v[84:87], v[28:31]
    s_waitcnt lgkmcnt(4)
    v_mfma_f32_16x16x32_bf16 v[32:35], v[112:115], v[88:91], v[32:35]
    ds_read_b64_tr_b16 v[100:101], v105 offset:16384
    ds_read_b64_tr_b16 v[102:103], v105 offset:18432
    v_mfma_f32_16x16x32_bf16 v[36:39], v[88:91], v[88:91], v[36:39]
    s_waitcnt lgkmcnt(4)
    v_mfma_f32_16x16x32_bf16 v[40:43], v[112:115], v[92:95], v[40:43]
    ds_read_b64_tr_b16 v[80:81], v106 offset:16384
    ds_read_b64_tr_b16 v[82:83], v106 offset:18432
    v_mfma_f32_16x16x32_bf16 v[44:47], v[92:95], v[92:95], v[44:47]
    s_waitcnt lgkmcnt(4)
    v_mfma_f32_16x16x32_bf16 v[16:19], v[112:115], v[96:99], v[16:19]
    ds_read_b64_tr_b16 v[84:85], v107 offset:16384
    ds_read_b64_tr_b16 v[86:87], v107 offset:18432
    v_mfma_f32_16x16x32_bf16 v[20:23], v[96:99], v[96:99], v[20:23]
    s_waitcnt lgkmcnt(4)
    v_mfma_f32_16x16x32_bf16 v[24:27], v[112:115], v[100:103], v[24:27]
    ds_read_b64_tr_b16 v[88:89], v104 offset:20480
    ds_read_b64_tr_b16 v[90:91], v104 offset:22528
    v_mfma_f32_16x16x32_bf16 v[28:31], v[100:103], v[100:103], v[28:31]
    s_waitcnt lgkmcnt(4)
    v_mfma_f32_16x16x32_bf16 v[32:35], v[112:115], v[80:83], v[32:35]
    ds_read_b64_tr_b16 v[92:93], v105 offset:20480
    ds_read_b64_tr_b16 v[94:95], v105 offset:22528
    v_mfma_f32_16x16x32_bf16 v[36:39], v[80:83], v[80:83], v[36:39]
    s_waitcnt lgkmcnt(4)
    v_mfma_f32_16x16x32_bf16 v[40:43], v[112:115], v[84:87], v[40:43]
    ds_read_b64_tr_b16 v[96:97], v106 offset:20480
    ds_read_b64_tr_b16 v[98:99], v106 offset:22528
    v_mfma_f32_16x16x32_bf16 v[44:47], v[84:87], v[84:87], v[44:47]
    s_waitcnt lgkmcnt(4)
    v_mfma_f32_16x16x32_bf16 v[16:19], v[112:115], v[88:91], v[16:19]
    ds_read_b64_tr_b16 v[100:101], v107 offset:20480
    ds_read_b64_tr_b16 v[102:103], v107 offset:22528
    v_mfma_f32_16x16x32_bf16 v[20:23], v[88:91], v[88:91], v[20:23]
    s_waitcnt lgkmcnt(4)
    v_mfma_f32_16x16x32_bf16 v[24:27], v[112:115], v[92:95], v[24:27]
    ds_read_b64_tr_b16 v[80:81], v104 offset:24576
    ds_read_b64_tr_b16 v[82:83], v104 offset:26624
    v_mfma_f32_16x16x32_bf16 v[28:31], v[92:95], v[92:95], v[28:31]
    s_waitcnt lgkmcnt(4)
    v_mfma_f32_16x16x32_bf16 v[32:35], v[112:115], v[96:99], v[32:35]
    ds_read_b64_tr_b16 v[84:85], v105 offset:24576
    ds_read_b64_tr_b16 v[86:87], v105 offset:26624
    v_mfma_f32_16x16x32_bf16 v[36:39], v[96:99], v[96:99], v[36:39]
    s_waitcnt lgkmcnt(4)
    v_mfma_f32_16x16x32_bf16 v[40:43], v[112:115], v[100:103], v[40:43]
    ds_read_b64_tr_b16 v[88:89], v106 offset:24576
    ds_read_b64_tr_b16 v[90:91], v106 offset:26624
    v_mfma_f32_16x16x32_bf16 v[44:47], v[100:103], v[100:103], v[44:47]
    s_waitcnt lgkmcnt(4)
    v_mfma_f32_16x16x32_bf16 v[16:19], v[112:115], v[80:83], v[16:19]
    ds_read_b64_tr_b16 v[92:93], v107 offset:24576
    ds_read_b64_tr_b16 v[94:95], v107 offset:26624
    v_mfma_f32_16x16x32_bf16 v[20:23], v[80:83], v[80:83], v[20:23]
    s_waitcnt lgkmcnt(4)
    v_mfma_f32_16x16x32_bf16 v[24:27], v[112:115], v[84:87], v[24:27]
    ds_read_b64_tr_b16 v[96:97], v104 offset:28672
    ds_read_b64_tr_b16 v[98:99], v104 offset:30720
    v_mfma_f32_16x16x32_bf16 v[28:31], v[84:87], v[84:87], v[28:31]
    s_waitcnt lgkmcnt(4)
    v_mfma_f32_16x16x32_bf16 v[32:35], v[112:115], v[88:91], v[32:35]
    ds_read_b64_tr_b16 v[100:101], v105 offset:28672
    ds_read_b64_tr_b16 v[102:103], v105 offset:30720
    v_mfma_f32_16x16x32_bf16 v[36:39], v[88:91], v[88:91], v[36:39]
    s_waitcnt lgkmcnt(4)
    v_mfma_f32_16x16x32_bf16 v[40:43], v[112:115], v[92:95], v[40:43]
    ds_read_b64_tr_b16 v[80:81], v106 offset:28672
    ds_read_b64_tr_b16 v[82:83], v106 offset:30720
    v_mfma_f32_16x16x32_bf16 v[44:47], v[92:95], v[92:95], v[44:47]
    s_waitcnt lgkmcnt(4)
    v_mfma_f32_16x16x32_bf16 v[16:19], v[112:115], v[96:99], v[16:19]
    ds_read_b64_tr_b16 v[84:85], v107 offset:28672
    ds_read_b64_tr_b16 v[86:87], v107 offset:30720
    v_mfma_f32_16x16x32_bf16 v[20:23], v[96:99], v[96:99], v[20:23]
    s_waitcnt vmcnt(0)
    s_barrier
    s_waitcnt lgkmcnt(4)
    v_mfma_f32_16x16x32_bf16 v[24:27], v[112:115], v[100:103], v[24:27]
    ds_read_b64_tr_b16 v[88:89], v104 offset:32768
    ds_read_b64_tr_b16 v[90:91], v104 offset:34816
    v_mfma_f32_16x16x32_bf16 v[28:31], v[100:103], v[100:103], v[28:31]
    s_waitcnt lgkmcnt(4)
    v_mfma_f32_16x16x32_bf16 v[32:35], v[112:115], v[80:83], v[32:35]
    ds_read_b64_tr_b16 v[92:93], v105 offset:32768
    ds_read_b64_tr_b16 v[94:95], v105 offset:34816
    v_mfma_f32_16x16x32_bf16 v[36:39], v[80:83], v[80:83], v[36:39]
    s_waitcnt lgkmcnt(4)
    v_mfma_f32_16x16x32_bf16 v[40:43], v[112:115], v[84:87], v[40:43]
    ds_read_b64_tr_b16 v[96:97], v106 offset:32768
    ds_read_b64_tr_b16 v[98:99], v106 offset:34816
    v_mfma_f32_16x16x32_bf16 v[44:47], v[84:87], v[84:87], v[44:47]
    s_waitcnt lgkmcnt(4)
    v_mfma_f32_16x16x32_bf16 v[16:19], v[112:115], v[88:91], v[16:19]
    ds_read_b64_tr_b16 v[100:101], v107 offset:32768
    ds_read_b64_tr_b16 v[102:103], v107 offset:34816
    v_mfma_f32_16x16x32_bf16 v[20:23], v[88:91], v[88:91], v[20:23]
    s_waitcnt lgkmcnt(4)
    v_mfma_f32_16x16x32_bf16 v[24:27], v[112:115], v[92:95], v[24:27]
    ds_read_b64_tr_b16 v[80:81], v104 offset:36864
    ds_read_b64_tr_b16 v[82:83], v104 offset:38912
    v_mfma_f32_16x16x32_bf16 v[28:31], v[92:95], v[92:95], v[28:31]
    s_waitcnt lgkmcnt(4)
    v_mfma_f32_16x16x32_bf16 v[32:35], v[112:115], v[96:99], v[32:35]
    ds_read_b64_tr_b16 v[84:85], v105 offset:36864
    ds_read_b64_tr_b16 v[86:87], v105 offset:38912
    v_mfma_f32_16x16x32_bf16 v[36:39], v[96:99], v[96:99], v[36:39]
    s_waitcnt lgkmcnt(4)
    v_mfma_f32_16x16x32_bf16 v[40:43], v[112:115], v[100:103], v[40:43]
    ds_read_b64_tr_b16 v[88:89], v106 offset:36864
    ds_read_b64_tr_b16 v[90:91], v106 offset:38912
    v_mfma_f32_16x16x32_bf16 v[44:47], v[100:103], v[100:103], v[44:47]
    s_waitcnt lgkmcnt(4)
    v_mfma_f32_16x16x32_bf16 v[16:19], v[112:115], v[80:83], v[16:19]
    ds_read_b64_tr_b16 v[92:93], v107 offset:36864
    ds_read_b64_tr_b16 v[94:95], v107 offset:38912
    v_mfma_f32_16x16x32_bf16 v[20:23], v[80:83], v[80:83], v[20:23]
    s_waitcnt lgkmcnt(4)
    v_mfma_f32_16x16x32_bf16 v[24:27], v[112:115], v[84:87], v[24:27]
    ds_read_b64_tr_b16 v[96:97], v104 offset:40960
    ds_read_b64_tr_b16 v[98:99], v104 offset:43008
    v_mfma_f32_16x16x32_bf16 v[28:31], v[84:87], v[84:87], v[28:31]
    s_waitcnt lgkmcnt(4)
    v_mfma_f32_16x16x32_bf16 v[32:35], v[112:115], v[88:91], v[32:35]
    ds_read_b64_tr_b16 v[100:101], v105 offset:40960
    ds_read_b64_tr_b16 v[102:103], v105 offset:43008
    v_mfma_f32_16x16x32_bf16 v[36:39], v[88:91], v[88:91], v[36:39]
    s_waitcnt lgkmcnt(4)
    v_mfma_f32_16x16x32_bf16 v[40:43], v[112:115], v[92:95], v[40:43]
    ds_read_b64_tr_b16 v[80:81], v106 offset:40960
    ds_read_b64_tr_b16 v[82:83], v106 offset:43008
    v_mfma_f32_16x16x32_bf16 v[44:47], v[92:95], v[92:95], v[44:47]
    s_waitcnt lgkmcnt(4)
    v_mfma_f32_16x16x32_bf16 v[16:19], v[112:115], v[96:99], v[16:19]
    ds_read_b64_tr_b16 v[84:85], v107 offset:40960
    ds_read_b64_tr_b16 v[86:87], v107 offset:43008
    v_mfma_f32_16x16x32_bf16 v[20:23], v[96:99], v[96:99], v[20:23]
    s_waitcnt lgkmcnt(4)
    v_mfma_f32_16x16x32_bf16 v[24:27], v[112:115], v[100:103], v[24:27]
    ds_read_b64_tr_b16 v[88:89], v104 offset:45056
    ds_read_b64_tr_b16 v[90:91], v104 offset:47104
    v_mfma_f32_16x16x32_bf16 v[28:31], v[100:103], v[100:103], v[28:31]
    s_waitcnt lgkmcnt(4)
    v_mfma_f32_16x16x32_bf16 v[32:35], v[112:115], v[80:83], v[32:35]
    ds_read_b64_tr_b16 v[92:93], v105 offset:45056
    ds_read_b64_tr_b16 v[94:95], v105 offset:47104
    v_mfma_f32_16x16x32_bf16 v[36:39], v[80:83], v[80:83], v[36:39]
    s_add_u32 m0, s12, 65536
    s_add_u32 s9, s10, 65536
    buffer_load_dwordx4 v6, s[68:71], s9 offen lds
    s_waitcnt lgkmcnt(4)
    v_mfma_f32_16x16x32_bf16 v[40:43], v[112:115], v[84:87], v[40:43]
    ds_read_b64_tr_b16 v[96:97], v106 offset:45056
    ds_read_b64_tr_b16 v[98:99], v106 offset:47104
    v_mfma_f32_16x16x32_bf16 v[44:47], v[84:87], v[84:87], v[44:47]
    s_waitcnt lgkmcnt(4)
    v_mfma_f32_16x16x32_bf16 v[16:19], v[112:115], v[88:91], v[16:19]
    ds_read_b64_tr_b16 v[100:101], v107 offset:45056
    ds_read_b64_tr_b16 v[102:103], v107 offset:47104
    v_mfma_f32_16x16x32_bf16 v[20:23], v[88:91], v[88:91], v[20:23]
    s_add_u32 m0, s12, 73728
    s_add_u32 s9, s10, 73728
    buffer_load_dwordx4 v6, s[68:71], s9 offen lds
    s_waitcnt lgkmcnt(4)
    v_mfma_f32_16x16x32_bf16 v[24:27], v[112:115], v[92:95], v[24:27]
    ds_read_b64_tr_b16 v[80:81], v104 offset:49152
    ds_read_b64_tr_b16 v[82:83], v104 offset:51200
    v_mfma_f32_16x16x32_bf16 v[28:31], v[92:95], v[92:95], v[28:31]
    s_waitcnt lgkmcnt(4)
    v_mfma_f32_16x16x32_bf16 v[32:35], v[112:115], v[96:99], v[32:35]
    ds_read_b64_tr_b16 v[84:85], v105 offset:49152
    ds_read_b64_tr_b16 v[86:87], v105 offset:51200
    v_mfma_f32_16x16x32_bf16 v[36:39], v[96:99], v[96:99], v[36:39]
    s_add_u32 m0, s12, 81920
    s_add_u32 s9, s10, 81920
    buffer_load_dwordx4 v6, s[68:71], s9 offen lds
    s_waitcnt lgkmcnt(4)
    v_mfma_f32_16x16x32_bf16 v[40:43], v[112:115], v[100:103], v[40:43]
    ds_read_b64_tr_b16 v[88:89], v106 offset:49152
    ds_read_b64_tr_b16 v[90:91], v106 offset:51200
    v_mfma_f32_16x16x32_bf16 v[44:47], v[100:103], v[100:103], v[44:47]
    s_waitcnt lgkmcnt(4)
    v_mfma_f32_16x16x32_bf16 v[16:19], v[112:115], v[80:83], v[16:19]
    ds_read_b64_tr_b16 v[92:93], v107 offset:49152
    ds_read_b64_tr_b16 v[94:95], v107 offset:51200
    v_mfma_f32_16x16x32_bf16 v[20:23], v[80:83], v[80:83], v[20:23]
    s_add_u32 m0, s12, 90112
    s_add_u32 s9, s10, 90112
    buffer_load_dwordx4 v6, s[68:71], s9 offen lds
    s_waitcnt lgkmcnt(4)
    v_mfma_f32_16x16x32_bf16 v[24:27], v[112:115], v[84:87], v[24:27]
    ds_read_b64_tr_b16 v[96:97], v104 offset:53248
    ds_read_b64_tr_b16 v[98:99], v104 offset:55296
    v_mfma_f32_16x16x32_bf16 v[28:31], v[84:87], v[84:87], v[28:31]
    s_waitcnt lgkmcnt(4)
    v_mfma_f32_16x16x32_bf16 v[32:35], v[112:115], v[88:91], v[32:35]
    ds_read_b64_tr_b16 v[100:101], v105 offset:53248
    ds_read_b64_tr_b16 v[102:103], v105 offset:55296
    v_mfma_f32_16x16x32_bf16 v[36:39], v[88:91], v[88:91], v[36:39]
    s_add_u32 m0, s12, 98304
    s_add_u32 s9, s10, 98304
    buffer_load_dwordx4 v6, s[68:71], s9 offen lds
    s_waitcnt lgkmcnt(4)
    v_mfma_f32_16x16x32_bf16 v[40:43], v[112:115], v[92:95], v[40:43]
    ds_read_b64_tr_b16 v[80:81], v106 offset:53248
    ds_read_b64_tr_b16 v[82:83], v106 offset:55296
    v_mfma_f32_16x16x32_bf16 v[44:47], v[92:95], v[92:95], v[44:47]
    s_waitcnt lgkmcnt(4)
    v_mfma_f32_16x16x32_bf16 v[16:19], v[112:115], v[96:99], v[16:19]
    ds_read_b64_tr_b16 v[84:85], v107 offset:53248
    ds_read_b64_tr_b16 v[86:87], v107 offset:55296
    v_mfma_f32_16x16x32_bf16 v[20:23], v[96:99], v[96:99], v[20:23]
    s_add_u32 m0, s12, 106496
    s_add_u32 s9, s10, 106496
    buffer_load_dwordx4 v6, s[68:71], s9 offen lds
    s_waitcnt lgkmcnt(4)
    v_mfma_f32_16x16x32_bf16 v[24:27], v[112:115], v[100:103], v[24:27]
    ds_read_b64_tr_b16 v[88:89], v104 offset:57344
    ds_read_b64_tr_b16 v[90:91], v104 offset:59392
    v_mfma_f32_16x16x32_bf16 v[28:31], v[100:103], v[100:103], v[28:31]
    s_waitcnt lgkmcnt(4)
    v_mfma_f32_16x16x32_bf16 v[32:35], v[112:115], v[80:83], v[32:35]
    ds_read_b64_tr_b16 v[92:93], v105 offset:57344
    ds_read_b64_tr_b16 v[94:95], v105 offset:59392
    v_mfma_f32_16x16x32_bf16 v[36:39], v[80:83], v[80:83], v[36:39]
    s_add_u32 m0, s12, 114688
    s_add_u32 s9, s10, 114688
    buffer_load_dwordx4 v6, s[68:71], s9 offen lds
    s_waitcnt lgkmcnt(4)
    v_mfma_f32_16x16x32_bf16 v[40:43], v[112:115], v[84:87], v[40:43]
    ds_read_b64_tr_b16 v[96:97], v106 offset:57344
    ds_read_b64_tr_b16 v[98:99], v106 offset:59392
    v_mfma_f32_16x16x32_bf16 v[44:47], v[84:87], v[84:87], v[44:47]
    s_waitcnt lgkmcnt(4)
    v_mfma_f32_16x16x32_bf16 v[16:19], v[112:115], v[88:91], v[16:19]
    ds_read_b64_tr_b16 v[100:101], v107 offset:57344
    ds_read_b64_tr_b16 v[102:103], v107 offset:59392
    v_mfma_f32_16x16x32_bf16 v[20:23], v[88:91], v[88:91], v[20:23]
    s_add_u32 m0, s12, 122880
    s_add_u32 s9, s10, 122880
    buffer_load_dwordx4 v6, s[68:71], s9 offen lds
    s_waitcnt lgkmcnt(4)
    v_mfma_f32_16x16x32_bf16 v[24:27], v[112:115], v[92:95], v[24:27]
    ds_read_b64_tr_b16 v[80:81], v104 offset:61440
    ds_read_b64_tr_b16 v[82:83], v104 offset:63488
    v_mfma_f32_16x16x32_bf16 v[28:31], v[92:95], v[92:95], v[28:31]
    s_waitcnt lgkmcnt(4)
    v_mfma_f32_16x16x32_bf16 v[32:35], v[112:115], v[96:99], v[32:35]
    ds_read_b64_tr_b16 v[84:85], v105 offset:61440
    ds_read_b64_tr_b16 v[86:87], v105 offset:63488
    v_mfma_f32_16x16x32_bf16 v[36:39], v[96:99], v[96:99], v[36:39]
    s_add_u32 s14, s62, 8192
    buffer_load_dwordx4 v[128:131], v5, s[68:71], s14 offen offset:0
    s_waitcnt lgkmcnt(4)
    v_mfma_f32_16x16x32_bf16 v[40:43], v[112:115], v[100:103], v[40:43]
    ds_read_b64_tr_b16 v[88:89], v106 offset:61440
    ds_read_b64_tr_b16 v[90:91], v106 offset:63488
    v_mfma_f32_16x16x32_bf16 v[44:47], v[100:103], v[100:103], v[44:47]
    s_waitcnt lgkmcnt(4)
    v_mfma_f32_16x16x32_bf16 v[16:19], v[112:115], v[80:83], v[16:19]
    ds_read_b64_tr_b16 v[92:93], v107 offset:61440
    ds_read_b64_tr_b16 v[94:95], v107 offset:63488
    v_mfma_f32_16x16x32_bf16 v[20:23], v[80:83], v[80:83], v[20:23]
    buffer_load_dwordx4 v[132:135], v5, s[68:71], s14 offen offset:1024
    s_waitcnt lgkmcnt(4)
    v_mfma_f32_16x16x32_bf16 v[24:27], v[112:115], v[84:87], v[24:27]
    v_mfma_f32_16x16x32_bf16 v[28:31], v[84:87], v[84:87], v[28:31]
    s_waitcnt lgkmcnt(2)
    v_mfma_f32_16x16x32_bf16 v[32:35], v[112:115], v[88:91], v[32:35]
    v_mfma_f32_16x16x32_bf16 v[36:39], v[88:91], v[88:91], v[36:39]
    buffer_load_dwordx4 v[136:139], v5, s[68:71], s14 offen offset:2048
    s_waitcnt lgkmcnt(0)
    v_mfma_f32_16x16x32_bf16 v[40:43], v[112:115], v[92:95], v[40:43]
    v_mfma_f32_16x16x32_bf16 v[44:47], v[92:95], v[92:95], v[44:47]
    s_setprio 2
    v_cndmask_b32 v20, v20, v21, s[52:53]
    v_cndmask_b32 v20, v20, v22, s[54:55]
    v_cndmask_b32 v20, v20, v23, s[44:45]
    v_cndmask_b32 v20, 0, v20, s[64:65]
    v_cndmask_b32 v28, v28, v29, s[52:53]
    v_cndmask_b32 v28, v28, v30, s[54:55]
    v_cndmask_b32 v28, v28, v31, s[44:45]
    v_cndmask_b32 v28, 0, v28, s[64:65]
    v_cndmask_b32 v36, v36, v37, s[52:53]
    v_cndmask_b32 v36, v36, v38, s[54:55]
    v_cndmask_b32 v36, v36, v39, s[44:45]
    v_cndmask_b32 v36, 0, v36, s[64:65]
    v_cndmask_b32 v44, v44, v45, s[52:53]
    v_cndmask_b32 v44, v44, v46, s[54:55]
    v_cndmask_b32 v44, v44, v47, s[44:45]
    v_cndmask_b32 v44, 0, v44, s[64:65]
    v_mov_b32 v21, v20
    v_mov_b32 v29, v28
    v_mov_b32 v37, v36
    v_mov_b32 v45, v44
    v_permlane32_swap_b32 v20, v21
    v_permlane32_swap_b32 v28, v29
    v_permlane32_swap_b32 v36, v37
    v_permlane32_swap_b32 v44, v45
    v_add_f32 v20, v20, v21
    v_add_f32 v28, v28, v29
    v_add_f32 v36, v36, v37
    v_add_f32 v44, v44, v45
    v_mov_b32 v21, v20
    v_mov_b32 v29, v28
    v_mov_b32 v37, v36
    v_mov_b32 v45, v44
    v_permlane16_swap_b32 v20, v21
    v_permlane16_swap_b32 v28, v29
    v_permlane16_swap_b32 v36, v37
    v_permlane16_swap_b32 v44, v45
    v_add_f32 v20, v20, v21
    v_add_f32 v28, v28, v29
    v_add_f32 v36, v36, v37
    v_add_f32 v44, v44, v45
    v_cmp_eq_u32 vcc, 1, v3
    s_nop 1
    v_cndmask_b32 v16, v16, v24, vcc
    v_cndmask_b32 v20, v20, v28, vcc
    v_cmp_eq_u32 vcc, 2, v3
    s_nop 1
    v_cndmask_b32 v16, v16, v32, vcc
    v_cndmask_b32 v20, v20, v36, vcc
    v_cmp_eq_u32 vcc, 3, v3
    s_nop 1
    v_cndmask_b32 v16, v16, v40, vcc
    v_cndmask_b32 v20, v20, v44, vcc
    v_mul_f32 v16, 0x3b000000, v16
    v_mul_f32 v20, 0x3b000000, v20
    v_fma_f32 v20, -v16, v16, v20
    v_max_f32 v20, 0, v20
    v_cvt_pk_bf16_f32 v21, v16, v20
    v_lshlrev_b32 v16, 16, v21
    v_and_b32 v20, 0xffff0000, v21
    v_add_f32 v20, 0x3727c5ac, v20
    v_cvt_pk_bf16_f32 v20, v20, v20
    v_lshlrev_b32 v20, 16, v20
    v_sqrt_f32 v20, v20
    s_nop 0
    v_cvt_pk_bf16_f32 v20, v20, v20
    v_lshlrev_b32 v20, 16, v20
    v_rcp_f32 v17, v20
    v_lshrrev_b32 v21, 1, v5
    v_add_u32 v21, 131072, v21
    ds_write_b64 v21, v[16:17]
    s_waitcnt lgkmcnt(0)
    s_waitcnt vmcnt(3)
    s_barrier
    ds_read_b64_tr_b16 v[96:97], v108 offset:0
    ds_read_b64_tr_b16 v[98:99], v108 offset:2048
    ds_read_b64_tr_b16 v[100:101], v109 offset:0
    ds_read_b64_tr_b16 v[102:103], v109 offset:2048
    ds_read_b64_tr_b16 v[80:81], v108 offset:4096
    ds_read_b64_tr_b16 v[82:83], v108 offset:6144
    s_waitcnt lgkmcnt(4)
    v_mfma_f32_16x16x32_bf16 v[48:51], v[112:115], v[96:99], 0
    ds_read_b64_tr_b16 v[84:85], v109 offset:4096
    ds_read_b64_tr_b16 v[86:87], v109 offset:6144
    v_mfma_f32_16x16x32_bf16 v[52:55], v[96:99], v[96:99], 0
    buffer_load_dwordx4 v[140:143], v5, s[68:71], s14 offen offset:3072
    s_waitcnt lgkmcnt(4)
    v_mfma_f32_16x16x32_bf16 v[56:59], v[112:115], v[100:103], 0
    ds_read_b64_tr_b16 v[88:89], v108 offset:8192
    ds_read_b64_tr_b16 v[90:91], v108 offset:10240
    v_mfma_f32_16x16x32_bf16 v[60:63], v[100:103], v[100:103], 0
    s_waitcnt lgkmcnt(4)
    v_mfma_f32_16x16x32_bf16 v[48:51], v[112:115], v[80:83], v[48:51]
    ds_read_b64_tr_b16 v[92:93], v109 offset:8192
    ds_read_b64_tr_b16 v[94:95], v109 offset:10240
    v_mfma_f32_16x16x32_bf16 v[52:55], v[80:83], v[80:83], v[52:55]
    s_add_u32 s14, s62, 12288
    buffer_load_dwordx4 v[144:147], v5, s[68:71], s14 offen offset:0
    s_waitcnt lgkmcnt(4)
    v_mfma_f32_16x16x32_bf16 v[56:59], v[112:115], v[84:87], v[56:59]
    ds_read_b64_tr_b16 v[96:97], v108 offset:12288
    ds_read_b64_tr_b16 v[98:99], v108 offset:14336
    v_mfma_f32_16x16x32_bf16 v[60:63], v[84:87], v[84:87], v[60:63]
    s_barrier
    s_waitcnt lgkmcnt(4)
    v_mfma_f32_16x16x32_bf16 v[48:51], v[112:115], v[88:91], v[48:51]
    ds_read_b64_tr_b16 v[100:101], v109 offset:12288
    ds_read_b64_tr_b16 v[102:103], v109 offset:14336
    v_mfma_f32_16x16x32_bf16 v[52:55], v[88:91], v[88:91], v[52:55]
    buffer_load_dwordx4 v[148:151], v5, s[68:71], s14 offen offset:1024
    s_waitcnt lgkmcnt(4)
    v_mfma_f32_16x16x32_bf16 v[56:59], v[112:115], v[92:95], v[56:59]
    ds_read_b64_tr_b16 v[80:81], v108 offset:16384
    ds_read_b64_tr_b16 v[82:83], v108 offset:18432
    v_mfma_f32_16x16x32_bf16 v[60:63], v[92:95], v[92:95], v[60:63]
    s_waitcnt lgkmcnt(4)
    v_mfma_f32_16x16x32_bf16 v[48:51], v[112:115], v[96:99], v[48:51]
    ds_read_b64_tr_b16 v[84:85], v109 offset:16384
    ds_read_b64_tr_b16 v[86:87], v109 offset:18432
    v_mfma_f32_16x16x32_bf16 v[52:55], v[96:99], v[96:99], v[52:55]
    s_add_u32 m0, s57, 0
    s_add_u32 s9, s62, 0
    buffer_load_dwordx4 v5, s[68:71], s9 offen offset:0 lds
    buffer_load_dwordx4 v[152:155], v5, s[68:71], s14 offen offset:2048
    s_waitcnt lgkmcnt(4)
    v_mfma_f32_16x16x32_bf16 v[56:59], v[112:115], v[100:103], v[56:59]
    ds_read_b64_tr_b16 v[88:89], v108 offset:20480
    ds_read_b64_tr_b16 v[90:91], v108 offset:22528
    v_mfma_f32_16x16x32_bf16 v[60:63], v[100:103], v[100:103], v[60:63]
    s_waitcnt lgkmcnt(4)
    v_mfma_f32_16x16x32_bf16 v[48:51], v[112:115], v[80:83], v[48:51]
    ds_read_b64_tr_b16 v[92:93], v109 offset:20480
    ds_read_b64_tr_b16 v[94:95], v109 offset:22528
    v_mfma_f32_16x16x32_bf16 v[52:55], v[80:83], v[80:83], v[52:55]
    buffer_load_dwordx4 v[156:159], v5, s[68:71], s14 offen offset:3072
    s_waitcnt lgkmcnt(4)
    v_mfma_f32_16x16x32_bf16 v[56:59], v[112:115], v[84:87], v[56:59]
    ds_read_b64_tr_b16 v[96:97], v108 offset:24576
    ds_read_b64_tr_b16 v[98:99], v108 offset:26624
    v_mfma_f32_16x16x32_bf16 v[60:63], v[84:87], v[84:87], v[60:63]
    s_add_u32 m0, s57, 0
    s_add_u32 s9, s62, 0
    buffer_load_dwordx4 v5, s[68:71], s9 offen offset:1024 lds
    s_waitcnt lgkmcnt(4)
    v_mfma_f32_16x16x32_bf16 v[48:51], v[112:115], v[88:91], v[48:51]
    ds_read_b64_tr_b16 v[100:101], v109 offset:24576
    ds_read_b64_tr_b16 v[102:103], v109 offset:26624
    v_mfma_f32_16x16x32_bf16 v[52:55], v[88:91], v[88:91], v[52:55]
    s_add_u32 s14, s62, 16384
    buffer_load_dwordx4 v[160:163], v5, s[68:71], s14 offen offset:0
    s_waitcnt lgkmcnt(4)
    v_mfma_f32_16x16x32_bf16 v[56:59], v[112:115], v[92:95], v[56:59]
    ds_read_b64_tr_b16 v[80:81], v108 offset:28672
    ds_read_b64_tr_b16 v[82:83], v108 offset:30720
    v_mfma_f32_16x16x32_bf16 v[60:63], v[92:95], v[92:95], v[60:63]
    s_waitcnt lgkmcnt(4)
    v_mfma_f32_16x16x32_bf16 v[48:51], v[112:115], v[96:99], v[48:51]
    ds_read_b64_tr_b16 v[84:85], v109 offset:28672
    ds_read_b64_tr_b16 v[86:87], v109 offset:30720
    v_mfma_f32_16x16x32_bf16 v[52:55], v[96:99], v[96:99], v[52:55]
    s_add_u32 m0, s57, 0
    s_add_u32 s9, s62, 0
    buffer_load_dwordx4 v5, s[68:71], s9 offen offset:2048 lds
    buffer_load_dwordx4 v[164:167], v5, s[68:71], s14 offen offset:1024
    s_waitcnt lgkmcnt(4)
    v_mfma_f32_16x16x32_bf16 v[56:59], v[112:115], v[100:103], v[56:59]
    ds_read_b64_tr_b16 v[88:89], v108 offset:32768
    ds_read_b64_tr_b16 v[90:91], v108 offset:34816
    v_mfma_f32_16x16x32_bf16 v[60:63], v[100:103], v[100:103], v[60:63]
    s_waitcnt lgkmcnt(4)
    v_mfma_f32_16x16x32_bf16 v[48:51], v[112:115], v[80:83], v[48:51]
    ds_read_b64_tr_b16 v[92:93], v109 offset:32768
    ds_read_b64_tr_b16 v[94:95], v109 offset:34816
    v_mfma_f32_16x16x32_bf16 v[52:55], v[80:83], v[80:83], v[52:55]
    buffer_load_dwordx4 v[168:171], v5, s[68:71], s14 offen offset:2048
    s_waitcnt lgkmcnt(4)
    v_mfma_f32_16x16x32_bf16 v[56:59], v[112:115], v[84:87], v[56:59]
    ds_read_b64_tr_b16 v[96:97], v108 offset:36864
    ds_read_b64_tr_b16 v[98:99], v108 offset:38912
    v_mfma_f32_16x16x32_bf16 v[60:63], v[84:87], v[84:87], v[60:63]
    s_add_u32 m0, s57, 0
    s_add_u32 s9, s62, 0
    buffer_load_dwordx4 v5, s[68:71], s9 offen offset:3072 lds
    s_waitcnt lgkmcnt(4)
    v_mfma_f32_16x16x32_bf16 v[48:51], v[112:115], v[88:91], v[48:51]
    ds_read_b64_tr_b16 v[100:101], v109 offset:36864
    ds_read_b64_tr_b16 v[102:103], v109 offset:38912
    v_mfma_f32_16x16x32_bf16 v[52:55], v[88:91], v[88:91], v[52:55]
    buffer_load_dwordx4 v[172:175], v5, s[68:71], s14 offen offset:3072
    s_waitcnt lgkmcnt(4)
    v_mfma_f32_16x16x32_bf16 v[56:59], v[112:115], v[92:95], v[56:59]
    ds_read_b64_tr_b16 v[80:81], v108 offset:40960
    ds_read_b64_tr_b16 v[82:83], v108 offset:43008
    v_mfma_f32_16x16x32_bf16 v[60:63], v[92:95], v[92:95], v[60:63]
    s_waitcnt lgkmcnt(4)
    v_mfma_f32_16x16x32_bf16 v[48:51], v[112:115], v[96:99], v[48:51]
    ds_read_b64_tr_b16 v[84:85], v109 offset:40960
    ds_read_b64_tr_b16 v[86:87], v109 offset:43008
    v_mfma_f32_16x16x32_bf16 v[52:55], v[96:99], v[96:99], v[52:55]
    s_add_u32 m0, s57, 4096
    s_add_u32 s9, s62, 4096
    buffer_load_dwordx4 v5, s[68:71], s9 offen offset:0 lds
    s_add_u32 s14, s62, 20480
    buffer_load_dwordx4 v[176:179], v5, s[68:71], s14 offen offset:0
    s_waitcnt lgkmcnt(4)
    v_mfma_f32_16x16x32_bf16 v[56:59], v[112:115], v[100:103], v[56:59]
    ds_read_b64_tr_b16 v[88:89], v108 offset:45056
    ds_read_b64_tr_b16 v[90:91], v108 offset:47104
    v_mfma_f32_16x16x32_bf16 v[60:63], v[100:103], v[100:103], v[60:63]
    s_waitcnt lgkmcnt(4)
    v_mfma_f32_16x16x32_bf16 v[48:51], v[112:115], v[80:83], v[48:51]
    ds_read_b64_tr_b16 v[92:93], v109 offset:45056
    ds_read_b64_tr_b16 v[94:95], v109 offset:47104
    v_mfma_f32_16x16x32_bf16 v[52:55], v[80:83], v[80:83], v[52:55]
    buffer_load_dwordx4 v[180:183], v5, s[68:71], s14 offen offset:1024
    s_waitcnt lgkmcnt(4)
    v_mfma_f32_16x16x32_bf16 v[56:59], v[112:115], v[84:87], v[56:59]
    ds_read_b64_tr_b16 v[96:97], v108 offset:49152
    ds_read_b64_tr_b16 v[98:99], v108 offset:51200
    v_mfma_f32_16x16x32_bf16 v[60:63], v[84:87], v[84:87], v[60:63]
    s_add_u32 m0, s57, 4096
    s_add_u32 s9, s62, 4096
    buffer_load_dwordx4 v5, s[68:71], s9 offen offset:1024 lds
    s_waitcnt lgkmcnt(4)
    v_mfma_f32_16x16x32_bf16 v[48:51], v[112:115], v[88:91], v[48:51]
    ds_read_b64_tr_b16 v[100:101], v109 offset:49152
    ds_read_b64_tr_b16 v[102:103], v109 offset:51200
    v_mfma_f32_16x16x32_bf16 v[52:55], v[88:91], v[88:91], v[52:55]
    buffer_load_dwordx4 v[184:187], v5, s[68:71], s14 offen offset:2048
    s_waitcnt lgkmcnt(4)
    v_mfma_f32_16x16x32_bf16 v[56:59], v[112:115], v[92:95], v[56:59]
    ds_read_b64_tr_b16 v[80:81], v108 offset:53248
    ds_read_b64_tr_b16 v[82:83], v108 offset:55296
    v_mfma_f32_16x16x32_bf16 v[60:63], v[92:95], v[92:95], v[60:63]
    s_waitcnt lgkmcnt(4)
    v_mfma_f32_16x16x32_bf16 v[48:51], v[112:115], v[96:99], v[48:51]
    ds_read_b64_tr_b16 v[84:85], v109 offset:53248
    ds_read_b64_tr_b16 v[86:87], v109 offset:55296
    v_mfma_f32_16x16x32_bf16 v[52:55], v[96:99], v[96:99], v[52:55]
    s_add_u32 m0, s57, 4096
    s_add_u32 s9, s62, 4096
    buffer_load_dwordx4 v5, s[68:71], s9 offen offset:2048 lds
    buffer_load_dwordx4 v[188:191], v5, s[68:71], s14 offen offset:3072
    s_waitcnt lgkmcnt(4)
    v_mfma_f32_16x16x32_bf16 v[56:59], v[112:115], v[100:103], v[56:59]
    ds_read_b64_tr_b16 v[88:89], v108 offset:57344
    ds_read_b64_tr_b16 v[90:91], v108 offset:59392
    v_mfma_f32_16x16x32_bf16 v[60:63], v[100:103], v[100:103], v[60:63]
    s_waitcnt lgkmcnt(4)
    v_mfma_f32_16x16x32_bf16 v[48:51], v[112:115], v[80:83], v[48:51]
    ds_read_b64_tr_b16 v[92:93], v109 offset:57344
    ds_read_b64_tr_b16 v[94:95], v109 offset:59392
    v_mfma_f32_16x16x32_bf16 v[52:55], v[80:83], v[80:83], v[52:55]
    s_add_u32 s14, s62, 24576
    buffer_load_dwordx4 v[192:195], v5, s[68:71], s14 offen offset:0
    s_waitcnt lgkmcnt(4)
    v_mfma_f32_16x16x32_bf16 v[56:59], v[112:115], v[84:87], v[56:59]
    ds_read_b64_tr_b16 v[96:97], v108 offset:61440
    ds_read_b64_tr_b16 v[98:99], v108 offset:63488
    v_mfma_f32_16x16x32_bf16 v[60:63], v[84:87], v[84:87], v[60:63]
    s_add_u32 m0, s57, 4096
    s_add_u32 s9, s62, 4096
    buffer_load_dwordx4 v5, s[68:71], s9 offen offset:3072 lds
    s_waitcnt lgkmcnt(4)
    v_mfma_f32_16x16x32_bf16 v[48:51], v[112:115], v[88:91], v[48:51]
    ds_read_b64_tr_b16 v[100:101], v109 offset:61440
    ds_read_b64_tr_b16 v[102:103], v109 offset:63488
    v_mfma_f32_16x16x32_bf16 v[52:55], v[88:91], v[88:91], v[52:55]
    buffer_load_dwordx4 v[196:199], v5, s[68:71], s14 offen offset:1024
    s_waitcnt lgkmcnt(4)
    v_mfma_f32_16x16x32_bf16 v[56:59], v[112:115], v[92:95], v[56:59]
    ds_read_b64_tr_b16 v[80:81], v110 offset:0
    ds_read_b64_tr_b16 v[82:83], v110 offset:2048
    v_mfma_f32_16x16x32_bf16 v[60:63], v[92:95], v[92:95], v[60:63]
    s_waitcnt lgkmcnt(4)
    v_mfma_f32_16x16x32_bf16 v[48:51], v[112:115], v[96:99], v[48:51]
    ds_read_b64_tr_b16 v[84:85], v111 offset:0
    ds_read_b64_tr_b16 v[86:87], v111 offset:2048
    v_mfma_f32_16x16x32_bf16 v[52:55], v[96:99], v[96:99], v[52:55]
    buffer_load_dwordx4 v[200:203], v5, s[68:71], s14 offen offset:2048
    s_waitcnt lgkmcnt(4)
    v_mfma_f32_16x16x32_bf16 v[56:59], v[112:115], v[100:103], v[56:59]
    ds_read_b64_tr_b16 v[88:89], v110 offset:4096
    ds_read_b64_tr_b16 v[90:91], v110 offset:6144
    v_mfma_f32_16x16x32_bf16 v[60:63], v[100:103], v[100:103], v[60:63]
    s_nop 1
    v_cndmask_b32 v52, v52, v53, s[52:53]
    v_cndmask_b32 v52, v52, v54, s[54:55]
    v_cndmask_b32 v52, v52, v55, s[44:45]
    v_cndmask_b32 v52, 0, v52, s[64:65]
    s_nop 1
    v_cndmask_b32 v60, v60, v61, s[52:53]
    v_cndmask_b32 v60, v60, v62, s[54:55]
    v_cndmask_b32 v60, v60, v63, s[44:45]
    v_cndmask_b32 v60, 0, v60, s[64:65]
    v_mov_b32 v53, v52
    v_mov_b32 v61, v60
    s_nop 0
    v_permlane32_swap_b32 v52, v53
    v_permlane32_swap_b32 v60, v61
    v_add_f32 v52, v52, v53
    v_add_f32 v60, v60, v61
    v_mov_b32 v53, v52
    v_mov_b32 v61, v60
    s_nop 0
    v_permlane16_swap_b32 v52, v53
    v_permlane16_swap_b32 v60, v61
    v_add_f32 v52, v52, v53
    v_add_f32 v60, v60, v61
    v_cmp_eq_u32 vcc, 1, v3
    s_nop 1
    v_cndmask_b32 v48, v48, v56, vcc
    v_cndmask_b32 v52, v52, v60, vcc
    v_mul_f32 v48, 0x3b000000, v48
    v_mul_f32 v52, 0x3b000000, v52
    v_fma_f32 v52, -v48, v48, v52
    v_max_f32 v52, 0, v52
    v_cvt_pk_bf16_f32 v53, v48, v52
    v_lshlrev_b32 v48, 16, v53
    v_and_b32 v52, 0xffff0000, v53
    v_add_f32 v52, 0x3727c5ac, v52
    v_cvt_pk_bf16_f32 v52, v52, v52
    v_lshlrev_b32 v52, 16, v52
    v_sqrt_f32 v52, v52
    s_nop 0
    v_cvt_pk_bf16_f32 v52, v52, v52
    v_lshlrev_b32 v52, 16, v52
    v_rcp_f32 v49, v52
    v_lshrrev_b32 v53, 1, v5
    v_add_u32 v53, 131584, v53
    s_mov_b64 exec, 0xffffffff
    ds_write_b64 v53, v[48:49]
    s_mov_b64 exec, -1
    s_waitcnt lgkmcnt(0)
    s_barrier
    s_waitcnt lgkmcnt(4)
    v_mfma_f32_16x16x32_bf16 v[64:67], v[112:115], v[80:83], 0
    ds_read_b64_tr_b16 v[92:93], v111 offset:4096
    ds_read_b64_tr_b16 v[94:95], v111 offset:6144
    v_mfma_f32_16x16x32_bf16 v[68:71], v[80:83], v[80:83], 0
    buffer_load_dwordx4 v[204:207], v5, s[68:71], s14 offen offset:3072
    s_waitcnt lgkmcnt(4)
    v_mfma_f32_16x16x32_bf16 v[72:75], v[112:115], v[84:87], 0
    ds_read_b64_tr_b16 v[96:97], v110 offset:8192
    ds_read_b64_tr_b16 v[98:99], v110 offset:10240
    v_mfma_f32_16x16x32_bf16 v[76:79], v[84:87], v[84:87], 0
    s_waitcnt lgkmcnt(4)
    v_mfma_f32_16x16x32_bf16 v[64:67], v[112:115], v[88:91], v[64:67]
    ds_read_b64_tr_b16 v[100:101], v111 offset:8192
    ds_read_b64_tr_b16 v[102:103], v111 offset:10240
    v_mfma_f32_16x16x32_bf16 v[68:71], v[88:91], v[88:91], v[68:71]
    s_waitcnt lgkmcnt(4)
    v_mfma_f32_16x16x32_bf16 v[72:75], v[112:115], v[92:95], v[72:75]
    ds_read_b64_tr_b16 v[80:81], v110 offset:12288
    ds_read_b64_tr_b16 v[82:83], v110 offset:14336
    v_mfma_f32_16x16x32_bf16 v[76:79], v[92:95], v[92:95], v[76:79]
    s_waitcnt lgkmcnt(4)
    v_mfma_f32_16x16x32_bf16 v[64:67], v[112:115], v[96:99], v[64:67]
    ds_read_b64_tr_b16 v[84:85], v111 offset:12288
    ds_read_b64_tr_b16 v[86:87], v111 offset:14336
    v_mfma_f32_16x16x32_bf16 v[68:71], v[96:99], v[96:99], v[68:71]
    s_waitcnt lgkmcnt(4)
    v_mfma_f32_16x16x32_bf16 v[72:75], v[112:115], v[100:103], v[72:75]
    ds_read_b64_tr_b16 v[88:89], v110 offset:16384
    ds_read_b64_tr_b16 v[90:91], v110 offset:18432
    v_mfma_f32_16x16x32_bf16 v[76:79], v[100:103], v[100:103], v[76:79]
    s_waitcnt lgkmcnt(4)
    v_mfma_f32_16x16x32_bf16 v[64:67], v[112:115], v[80:83], v[64:67]
    ds_read_b64_tr_b16 v[92:93], v111 offset:16384
    ds_read_b64_tr_b16 v[94:95], v111 offset:18432
    v_mfma_f32_16x16x32_bf16 v[68:71], v[80:83], v[80:83], v[68:71]
    s_waitcnt lgkmcnt(4)
    v_mfma_f32_16x16x32_bf16 v[72:75], v[112:115], v[84:87], v[72:75]
    ds_read_b64_tr_b16 v[96:97], v110 offset:20480
    ds_read_b64_tr_b16 v[98:99], v110 offset:22528
    v_mfma_f32_16x16x32_bf16 v[76:79], v[84:87], v[84:87], v[76:79]
    s_waitcnt lgkmcnt(4)
    v_mfma_f32_16x16x32_bf16 v[64:67], v[112:115], v[88:91], v[64:67]
    ds_read_b64_tr_b16 v[100:101], v111 offset:20480
    ds_read_b64_tr_b16 v[102:103], v111 offset:22528
    v_mfma_f32_16x16x32_bf16 v[68:71], v[88:91], v[88:91], v[68:71]
    s_waitcnt lgkmcnt(4)
    v_mfma_f32_16x16x32_bf16 v[72:75], v[112:115], v[92:95], v[72:75]
    ds_read_b64_tr_b16 v[80:81], v110 offset:24576
    ds_read_b64_tr_b16 v[82:83], v110 offset:26624
    v_mfma_f32_16x16x32_bf16 v[76:79], v[92:95], v[92:95], v[76:79]
    s_waitcnt lgkmcnt(4)
    v_mfma_f32_16x16x32_bf16 v[64:67], v[112:115], v[96:99], v[64:67]
    ds_read_b64_tr_b16 v[84:85], v111 offset:24576
    ds_read_b64_tr_b16 v[86:87], v111 offset:26624
    v_mfma_f32_16x16x32_bf16 v[68:71], v[96:99], v[96:99], v[68:71]
    s_waitcnt lgkmcnt(4)
    v_mfma_f32_16x16x32_bf16 v[72:75], v[112:115], v[100:103], v[72:75]
    ds_read_b64_tr_b16 v[88:89], v110 offset:28672
    ds_read_b64_tr_b16 v[90:91], v110 offset:30720
    v_mfma_f32_16x16x32_bf16 v[76:79], v[100:103], v[100:103], v[76:79]
    s_waitcnt lgkmcnt(4)
    v_mfma_f32_16x16x32_bf16 v[64:67], v[112:115], v[80:83], v[64:67]
    ds_read_b64_tr_b16 v[92:93], v111 offset:28672
    ds_read_b64_tr_b16 v[94:95], v111 offset:30720
    v_mfma_f32_16x16x32_bf16 v[68:71], v[80:83], v[80:83], v[68:71]
    s_waitcnt lgkmcnt(4)
    v_mfma_f32_16x16x32_bf16 v[72:75], v[112:115], v[84:87], v[72:75]
    ds_read_b64_tr_b16 v[96:97], v110 offset:32768
    ds_read_b64_tr_b16 v[98:99], v110 offset:34816
    v_mfma_f32_16x16x32_bf16 v[76:79], v[84:87], v[84:87], v[76:79]
    s_waitcnt lgkmcnt(4)
    v_mfma_f32_16x16x32_bf16 v[64:67], v[112:115], v[88:91], v[64:67]
    ds_read_b64_tr_b16 v[100:101], v111 offset:32768
    ds_read_b64_tr_b16 v[102:103], v111 offset:34816
    v_mfma_f32_16x16x32_bf16 v[68:71], v[88:91], v[88:91], v[68:71]
    s_waitcnt lgkmcnt(4)
    v_mfma_f32_16x16x32_bf16 v[72:75], v[112:115], v[92:95], v[72:75]
    ds_read_b64_tr_b16 v[80:81], v110 offset:36864
    ds_read_b64_tr_b16 v[82:83], v110 offset:38912
    v_mfma_f32_16x16x32_bf16 v[76:79], v[92:95], v[92:95], v[76:79]
    s_waitcnt lgkmcnt(4)
    v_mfma_f32_16x16x32_bf16 v[64:67], v[112:115], v[96:99], v[64:67]
    ds_read_b64_tr_b16 v[84:85], v111 offset:36864
    ds_read_b64_tr_b16 v[86:87], v111 offset:38912
    v_mfma_f32_16x16x32_bf16 v[68:71], v[96:99], v[96:99], v[68:71]
    s_waitcnt lgkmcnt(4)
    v_mfma_f32_16x16x32_bf16 v[72:75], v[112:115], v[100:103], v[72:75]
    ds_read_b64_tr_b16 v[88:89], v110 offset:40960
    ds_read_b64_tr_b16 v[90:91], v110 offset:43008
    v_mfma_f32_16x16x32_bf16 v[76:79], v[100:103], v[100:103], v[76:79]
    s_waitcnt lgkmcnt(4)
    v_mfma_f32_16x16x32_bf16 v[64:67], v[112:115], v[80:83], v[64:67]
    ds_read_b64_tr_b16 v[92:93], v111 offset:40960
    ds_read_b64_tr_b16 v[94:95], v111 offset:43008
    v_mfma_f32_16x16x32_bf16 v[68:71], v[80:83], v[80:83], v[68:71]
    s_waitcnt lgkmcnt(4)
    v_mfma_f32_16x16x32_bf16 v[72:75], v[112:115], v[84:87], v[72:75]
    ds_read_b64_tr_b16 v[96:97], v110 offset:45056
    ds_read_b64_tr_b16 v[98:99], v110 offset:47104
    v_mfma_f32_16x16x32_bf16 v[76:79], v[84:87], v[84:87], v[76:79]
    s_waitcnt lgkmcnt(4)
    v_mfma_f32_16x16x32_bf16 v[64:67], v[112:115], v[88:91], v[64:67]
    ds_read_b64_tr_b16 v[100:101], v111 offset:45056
    ds_read_b64_tr_b16 v[102:103], v111 offset:47104
    v_mfma_f32_16x16x32_bf16 v[68:71], v[88:91], v[88:91], v[68:71]
    s_waitcnt lgkmcnt(4)
    v_mfma_f32_16x16x32_bf16 v[72:75], v[112:115], v[92:95], v[72:75]
    ds_read_b64_tr_b16 v[80:81], v110 offset:49152
    ds_read_b64_tr_b16 v[82:83], v110 offset:51200
    v_mfma_f32_16x16x32_bf16 v[76:79], v[92:95], v[92:95], v[76:79]
    s_waitcnt lgkmcnt(4)
    v_mfma_f32_16x16x32_bf16 v[64:67], v[112:115], v[96:99], v[64:67]
    ds_read_b64_tr_b16 v[84:85], v111 offset:49152
    ds_read_b64_tr_b16 v[86:87], v111 offset:51200
    v_mfma_f32_16x16x32_bf16 v[68:71], v[96:99], v[96:99], v[68:71]
    s_waitcnt lgkmcnt(4)
    v_mfma_f32_16x16x32_bf16 v[72:75], v[112:115], v[100:103], v[72:75]
    ds_read_b64_tr_b16 v[88:89], v110 offset:53248
    ds_read_b64_tr_b16 v[90:91], v110 offset:55296
    v_mfma_f32_16x16x32_bf16 v[76:79], v[100:103], v[100:103], v[76:79]
    s_waitcnt lgkmcnt(4)
    v_mfma_f32_16x16x32_bf16 v[64:67], v[112:115], v[80:83], v[64:67]
    ds_read_b64_tr_b16 v[92:93], v111 offset:53248
    ds_read_b64_tr_b16 v[94:95], v111 offset:55296
    v_mfma_f32_16x16x32_bf16 v[68:71], v[80:83], v[80:83], v[68:71]
    s_waitcnt lgkmcnt(4)
    v_mfma_f32_16x16x32_bf16 v[72:75], v[112:115], v[84:87], v[72:75]
    ds_read_b64_tr_b16 v[96:97], v110 offset:57344
    ds_read_b64_tr_b16 v[98:99], v110 offset:59392
    v_mfma_f32_16x16x32_bf16 v[76:79], v[84:87], v[84:87], v[76:79]
    s_waitcnt lgkmcnt(4)
    v_mfma_f32_16x16x32_bf16 v[64:67], v[112:115], v[88:91], v[64:67]
    ds_read_b64_tr_b16 v[100:101], v111 offset:57344
    ds_read_b64_tr_b16 v[102:103], v111 offset:59392
    v_mfma_f32_16x16x32_bf16 v[68:71], v[88:91], v[88:91], v[68:71]
    s_waitcnt lgkmcnt(4)
    v_mfma_f32_16x16x32_bf16 v[72:75], v[112:115], v[92:95], v[72:75]
    ds_read_b64_tr_b16 v[80:81], v110 offset:61440
    ds_read_b64_tr_b16 v[82:83], v110 offset:63488
    v_mfma_f32_16x16x32_bf16 v[76:79], v[92:95], v[92:95], v[76:79]
    s_waitcnt lgkmcnt(4)
    v_mfma_f32_16x16x32_bf16 v[64:67], v[112:115], v[96:99], v[64:67]
    ds_read_b64_tr_b16 v[84:85], v111 offset:61440
    ds_read_b64_tr_b16 v[86:87], v111 offset:63488
    v_mfma_f32_16x16x32_bf16 v[68:71], v[96:99], v[96:99], v[68:71]
    s_waitcnt lgkmcnt(4)
    v_mfma_f32_16x16x32_bf16 v[72:75], v[112:115], v[100:103], v[72:75]
    v_mfma_f32_16x16x32_bf16 v[76:79], v[100:103], v[100:103], v[76:79]
    s_waitcnt lgkmcnt(2)
    v_mfma_f32_16x16x32_bf16 v[64:67], v[112:115], v[80:83], v[64:67]
    v_mfma_f32_16x16x32_bf16 v[68:71], v[80:83], v[80:83], v[68:71]
    s_waitcnt lgkmcnt(0)
    v_mfma_f32_16x16x32_bf16 v[72:75], v[112:115], v[84:87], v[72:75]
    v_mfma_f32_16x16x32_bf16 v[76:79], v[84:87], v[84:87], v[76:79]
    s_nop 4
    v_cndmask_b32 v68, v68, v69, s[52:53]
    v_cndmask_b32 v68, v68, v70, s[54:55]
    v_cndmask_b32 v68, v68, v71, s[44:45]
    v_cndmask_b32 v68, 0, v68, s[64:65]
    v_cndmask_b32 v76, v76, v77, s[52:53]
    v_cndmask_b32 v76, v76, v78, s[54:55]
    v_cndmask_b32 v76, v76, v79, s[44:45]
    v_cndmask_b32 v76, 0, v76, s[64:65]
    v_mov_b32 v69, v68
    v_mov_b32 v77, v76
    s_nop 0
    v_permlane32_swap_b32 v68, v69
    v_permlane32_swap_b32 v76, v77
    v_add_f32 v68, v68, v69
    v_add_f32 v76, v76, v77
    v_mov_b32 v69, v68
    v_mov_b32 v77, v76
    s_nop 0
    v_permlane16_swap_b32 v68, v69
    v_permlane16_swap_b32 v76, v77
    v_add_f32 v68, v68, v69
    v_add_f32 v76, v76, v77
    v_cmp_eq_u32 vcc, 1, v3
    s_nop 1
    v_cndmask_b32 v64, v64, v72, vcc
    v_cndmask_b32 v68, v68, v76, vcc
    v_mul_f32 v64, 0x3b000000, v64
    v_mul_f32 v68, 0x3b000000, v68
    v_fma_f32 v68, -v64, v64, v68
    v_max_f32 v68, 0, v68
    v_cvt_pk_bf16_f32 v69, v64, v68
    v_lshlrev_b32 v64, 16, v69
    v_and_b32 v68, 0xffff0000, v69
    v_add_f32 v68, 0x3727c5ac, v68
    v_cvt_pk_bf16_f32 v68, v68, v68
    v_lshlrev_b32 v68, 16, v68
    v_sqrt_f32 v68, v68
    s_nop 0
    v_cvt_pk_bf16_f32 v68, v68, v68
    v_lshlrev_b32 v68, 16, v68
    v_rcp_f32 v65, v68
    v_lshrrev_b32 v69, 1, v5
    v_add_u32 v69, 131840, v69
    s_mov_b64 exec, 0xffffffff
    ds_write_b64 v69, v[64:65]
    s_mov_b64 exec, -1
    s_waitcnt lgkmcnt(0)
    s_barrier
    v_lshlrev_b32 v8, 2, v4
    s_mov_b32 s65, 0
    s_nop 1
KB_F0_POLL:
    buffer_load_dword v10, v8, s[68:71], s67 offen offset:0 sc1
    s_waitcnt vmcnt(0)
    v_cmp_ne_u32 vcc, 1, v10
    s_nop 1
    s_cmp_eq_u64 vcc, 0
    s_nop 1
    s_cbranch_scc1 KB_F0_OK
    s_add_u32 s65, s65, 1
    s_cmp_ge_u32 s65, 262144
    s_cbranch_scc1 KB_F0_OK
    s_sleep 1
    s_branch KB_F0_POLL
KB_F0_OK:
    v_mov_b32 v10, 1
    ds_write_b32 v7, v10 offset:1032
    s_waitcnt lgkmcnt(0)
    s_nop 0
KB_F0_X:
    s_setprio 0
KB_P2:
    v_mov_b32 v7, 131072
    v_lshlrev_b32 v8, 2, v4
    s_lshr_b32 s9, s3, 1
    s_and_b32 s14, s9, 1
    s_lshr_b32 s9, s9, 1
    s_lshl_b32 s13, s58, 1
    s_add_u32 s14, s14, s13
    s_lshl_b32 s13, s60, 1
    s_add_u32 s13, s13, s9
    v_lshlrev_b32 v14, 11, v3
    v_lshl_add_u32 v14, v4, 1, v14
    s_lshl_b32 s64, s13, 16
    s_lshl_b32 s9, s61, 13
    s_add_u32 s64, s64, s9
    s_and_b32 s9, s3, 1
    s_lshl_b32 s9, s9, 10
    s_add_u32 s64, s64, s9
    s_lshl_b32 s9, s14, 5
    s_add_u32 s64, s64, s9
    s_add_u32 s64, s64, 9437184
    buffer_load_ushort v0, v14, s[68:71], s64 offen offset:0
    buffer_load_ushort v1, v14, s[68:71], s64 offen offset:128
    buffer_load_ushort v2, v14, s[68:71], s64 offen offset:256
    buffer_load_ushort v6, v14, s[68:71], s64 offen offset:384
    buffer_load_ushort v9, v14, s[68:71], s64 offen offset:512
    buffer_load_ushort v11, v14, s[68:71], s64 offen offset:640
    buffer_load_ushort v12, v14, s[68:71], s64 offen offset:768
    buffer_load_ushort v13, v14, s[68:71], s64 offen offset:896
    s_lshl_b32 s64, s13, 16
    s_lshl_b32 s9, s14, 14
    s_add_u32 s64, s64, s9
    s_lshl_b32 s9, s61, 7
    s_add_u32 s64, s64, s9
    s_and_b32 s9, s3, 1
    s_lshl_b32 s9, s9, 4
    s_add_u32 s64, s64, s9
    v_add_u32 v15, s57, v5
    s_nop 2
KB_SPE:
    ds_read_b32 v10, v7 offset:1032
    s_waitcnt lgkmcnt(0)
    v_readfirstlane_b32 s9, v10
    s_nop 1
    s_cmp_eq_u32 s9, 1
    s_nop 1
    s_cbranch_scc1 KB_SPE_GO
    s_sleep 1
    s_branch KB_SPE
KB_SPE_GO:
    s_waitcnt vmcnt(8)
    s_cmp_eq_u32 s3, 3
    s_cbranch_scc1 KB_S1
    s_mov_b64 exec, 1
    v_mov_b32 v10, 1
    ds_add_rtn_u32 v14, v7, v10 offset:1028
    s_waitcnt lgkmcnt(0)
    v_readfirstlane_b32 s9, v14
    s_nop 1
    s_cmp_lg_u32 s9, 6
    s_nop 1
    s_cbranch_scc1 KB_S1
    s_mov_b64 exec, 0xffff
    v_mov_b32 v10, 1
    v_lshlrev_b32 v14, 7, v4
    buffer_store_dword v10, v14, s[68:71], s66 offen offset:64 sc1
    s_waitcnt vmcnt(0)
    s_nop 0
KB_S1:
    s_mov_b64 exec, -1
    s_add_u32 s13, s63, 0
    buffer_load_dwordx4 v[80:83], v5, s[68:71], s13 offen offset:0 sc1
    s_add_u32 s14, s63, 57344
    buffer_load_dwordx4 v[84:87], v5, s[68:71], s14 offen offset:0 sc1
    buffer_load_dwordx4 v[88:91], v5, s[68:71], s13 offen offset:1024 sc1
    buffer_load_dwordx4 v[92:95], v5, s[68:71], s14 offen offset:1024 sc1
    buffer_load_dwordx4 v[96:99], v5, s[68:71], s13 offen offset:2048 sc1
    buffer_load_dwordx4 v[100:103], v5, s[68:71], s14 offen offset:2048 sc1
    ds_read_b128 v[208:211], v15 offset:0
    ds_read_b128 v[212:215], v15 offset:1024
    ds_read_b128 v[216:219], v15 offset:2048
    ds_read_b128 v[220:223], v15 offset:3072
    ds_read_b128 v[224:227], v15 offset:4096
    ds_read_b128 v[228:231], v15 offset:5120
    ds_read_b128 v[232:235], v15 offset:6144
    ds_read_b128 v[236:239], v15 offset:7168
    s_waitcnt lgkmcnt(0)
    s_waitcnt vmcnt(4)
    v_mfma_f32_16x16x32_bf16 v[16:19], v[208:211], v[80:83], 0
    v_mfma_f32_16x16x32_bf16 v[20:23], v[208:211], v[84:87], 0
    buffer_load_dwordx4 v[104:107], v5, s[68:71], s13 offen offset:3072 sc1
    v_mfma_f32_16x16x32_bf16 v[32:35], v[212:215], v[80:83], 0
    v_mfma_f32_16x16x32_bf16 v[36:39], v[212:215], v[84:87], 0
    v_mfma_f32_16x16x32_bf16 v[48:51], v[216:219], v[80:83], 0
    buffer_load_dwordx4 v[108:111], v5, s[68:71], s14 offen offset:3072 sc1
    v_mfma_f32_16x16x32_bf16 v[52:55], v[216:219], v[84:87], 0
    v_mfma_f32_16x16x32_bf16 v[64:67], v[220:223], v[80:83], 0
    v_mfma_f32_16x16x32_bf16 v[68:71], v[220:223], v[84:87], 0
    s_waitcnt vmcnt(4)
    v_mfma_f32_16x16x32_bf16 v[16:19], v[224:227], v[88:91], v[16:19]
    v_mfma_f32_16x16x32_bf16 v[20:23], v[224:227], v[92:95], v[20:23]
    s_add_u32 s13, s63, 4096
    buffer_load_dwordx4 v[112:115], v5, s[68:71], s13 offen offset:0 sc1
    v_mfma_f32_16x16x32_bf16 v[32:35], v[228:231], v[88:91], v[32:35]
    v_mfma_f32_16x16x32_bf16 v[36:39], v[228:231], v[92:95], v[36:39]
    v_mfma_f32_16x16x32_bf16 v[48:51], v[232:235], v[88:91], v[48:51]
    s_add_u32 s14, s63, 61440
    buffer_load_dwordx4 v[116:119], v5, s[68:71], s14 offen offset:0 sc1
    v_mfma_f32_16x16x32_bf16 v[52:55], v[232:235], v[92:95], v[52:55]
    v_mfma_f32_16x16x32_bf16 v[64:67], v[236:239], v[88:91], v[64:67]
    v_mfma_f32_16x16x32_bf16 v[68:71], v[236:239], v[92:95], v[68:71]
    s_waitcnt vmcnt(4)
    v_mfma_f32_16x16x32_bf16 v[16:19], v[128:131], v[96:99], v[16:19]
    v_mfma_f32_16x16x32_bf16 v[20:23], v[128:131], v[100:103], v[20:23]
    buffer_load_dwordx4 v[120:123], v5, s[68:71], s13 offen offset:1024 sc1
    v_mfma_f32_16x16x32_bf16 v[32:35], v[132:135], v[96:99], v[32:35]
    v_mfma_f32_16x16x32_bf16 v[36:39], v[132:135], v[100:103], v[36:39]
    v_mfma_f32_16x16x32_bf16 v[48:51], v[136:139], v[96:99], v[48:51]
    buffer_load_dwordx4 v[124:127], v5, s[68:71], s14 offen offset:1024 sc1
    v_mfma_f32_16x16x32_bf16 v[52:55], v[136:139], v[100:103], v[52:55]
    v_mfma_f32_16x16x32_bf16 v[64:67], v[140:143], v[96:99], v[64:67]
    v_mfma_f32_16x16x32_bf16 v[68:71], v[140:143], v[100:103], v[68:71]
    s_waitcnt vmcnt(4)
    v_mfma_f32_16x16x32_bf16 v[16:19], v[144:147], v[104:107], v[16:19]
    v_mfma_f32_16x16x32_bf16 v[20:23], v[144:147], v[108:111], v[20:23]
    buffer_load_dwordx4 v[240:243], v5, s[68:71], s13 offen offset:2048 sc1
    v_mfma_f32_16x16x32_bf16 v[32:35], v[148:151], v[104:107], v[32:35]
    v_mfma_f32_16x16x32_bf16 v[36:39], v[148:151], v[108:111], v[36:39]
    v_mfma_f32_16x16x32_bf16 v[48:51], v[152:155], v[104:107], v[48:51]
    buffer_load_dwordx4 v[244:247], v5, s[68:71], s14 offen offset:2048 sc1
    v_mfma_f32_16x16x32_bf16 v[52:55], v[152:155], v[108:111], v[52:55]
    v_mfma_f32_16x16x32_bf16 v[64:67], v[156:159], v[104:107], v[64:67]
    v_mfma_f32_16x16x32_bf16 v[68:71], v[156:159], v[108:111], v[68:71]
    s_waitcnt vmcnt(4)
    v_mfma_f32_16x16x32_bf16 v[16:19], v[160:163], v[112:115], v[16:19]
    v_mfma_f32_16x16x32_bf16 v[20:23], v[160:163], v[116:119], v[20:23]
    v_mfma_f32_16x16x32_bf16 v[32:35], v[164:167], v[112:115], v[32:35]
    v_mfma_f32_16x16x32_bf16 v[36:39], v[164:167], v[116:119], v[36:39]
    v_mfma_f32_16x16x32_bf16 v[48:51], v[168:171], v[112:115], v[48:51]
    v_mfma_f32_16x16x32_bf16 v[52:55], v[168:171], v[116:119], v[52:55]
    v_mfma_f32_16x16x32_bf16 v[64:67], v[172:175], v[112:115], v[64:67]
    v_mfma_f32_16x16x32_bf16 v[68:71], v[172:175], v[116:119], v[68:71]
    s_waitcnt vmcnt(2)
    v_mfma_f32_16x16x32_bf16 v[16:19], v[176:179], v[120:123], v[16:19]
    v_mfma_f32_16x16x32_bf16 v[20:23], v[176:179], v[124:127], v[20:23]
    v_mfma_f32_16x16x32_bf16 v[32:35], v[180:183], v[120:123], v[32:35]
    v_mfma_f32_16x16x32_bf16 v[36:39], v[180:183], v[124:127], v[36:39]
    v_mfma_f32_16x16x32_bf16 v[48:51], v[184:187], v[120:123], v[48:51]
    v_mfma_f32_16x16x32_bf16 v[52:55], v[184:187], v[124:127], v[52:55]
    v_mfma_f32_16x16x32_bf16 v[64:67], v[188:191], v[120:123], v[64:67]
    v_mfma_f32_16x16x32_bf16 v[68:71], v[188:191], v[124:127], v[68:71]
    s_cmp_lg_u32 s3, 3
    s_nop 6
    s_cbranch_scc1 KB_SPL
    s_mov_b32 s65, 0
KB_F1_POLL:
    buffer_load_dword v10, v8, s[68:71], s67 offen offset:64 sc1
    s_waitcnt vmcnt(0)
    v_cmp_ne_u32 vcc, 1, v10
    s_nop 1
    s_cmp_eq_u64 vcc, 0
    s_nop 1
    s_cbranch_scc1 KB_F1_OK
    s_add_u32 s65, s65, 1
    s_cmp_ge_u32 s65, 262144
    s_cbranch_scc1 KB_F1_OK
    s_sleep 1
    s_branch KB_F1_POLL
KB_F1_OK:
    v_mov_b32 v10, 1
    ds_write_b32 v7, v10 offset:1036
    s_waitcnt lgkmcnt(0)
    s_nop 0
KB_F1_X:
KB_SPL:
    ds_read_b32 v10, v7 offset:1036
    s_waitcnt lgkmcnt(0)
    v_readfirstlane_b32 s9, v10
    s_nop 1
    s_cmp_eq_u32 s9, 1
    s_nop 1
    s_cbranch_scc1 KB_SPL_GO
    s_sleep 1
    s_branch KB_SPL
KB_SPL_GO:
    s_add_u32 s13, s63, 229376
    buffer_load_dwordx4 v[248:251], v5, s[68:71], s13 offen offset:0 sc1
    s_add_u32 s14, s63, 286720
    buffer_load_dwordx4 v[252:255], v5, s[68:71], s14 offen offset:0 sc1
    buffer_load_dwordx4 v[80:83], v5, s[68:71], s13 offen offset:1024 sc1
    buffer_load_dwordx4 v[84:87], v5, s[68:71], s14 offen offset:1024 sc1
    buffer_load_dwordx4 v[88:91], v5, s[68:71], s13 offen offset:2048 sc1
    buffer_load_dwordx4 v[92:95], v5, s[68:71], s14 offen offset:2048 sc1
    s_waitcnt vmcnt(6)
    v_mfma_f32_16x16x32_bf16 v[16:19], v[192:195], v[240:243], v[16:19]
    v_mfma_f32_16x16x32_bf16 v[20:23], v[192:195], v[244:247], v[20:23]
    v_mfma_f32_16x16x32_bf16 v[32:35], v[196:199], v[240:243], v[32:35]
    v_mfma_f32_16x16x32_bf16 v[36:39], v[196:199], v[244:247], v[36:39]
    v_mfma_f32_16x16x32_bf16 v[48:51], v[200:203], v[240:243], v[48:51]
    v_mfma_f32_16x16x32_bf16 v[52:55], v[200:203], v[244:247], v[52:55]
    v_mfma_f32_16x16x32_bf16 v[64:67], v[204:207], v[240:243], v[64:67]
    v_mfma_f32_16x16x32_bf16 v[68:71], v[204:207], v[244:247], v[68:71]
    s_waitcnt vmcnt(4)
    v_mfma_f32_16x16x32_bf16 v[24:27], v[208:211], v[248:251], 0
    v_mfma_f32_16x16x32_bf16 v[28:31], v[208:211], v[252:255], 0
    buffer_load_dwordx4 v[96:99], v5, s[68:71], s13 offen offset:3072 sc1
    v_mfma_f32_16x16x32_bf16 v[40:43], v[212:215], v[248:251], 0
    v_mfma_f32_16x16x32_bf16 v[44:47], v[212:215], v[252:255], 0
    v_mfma_f32_16x16x32_bf16 v[56:59], v[216:219], v[248:251], 0
    buffer_load_dwordx4 v[100:103], v5, s[68:71], s14 offen offset:3072 sc1
    v_mfma_f32_16x16x32_bf16 v[60:63], v[216:219], v[252:255], 0
    v_mfma_f32_16x16x32_bf16 v[72:75], v[220:223], v[248:251], 0
    v_mfma_f32_16x16x32_bf16 v[76:79], v[220:223], v[252:255], 0
    s_waitcnt vmcnt(4)
    v_mfma_f32_16x16x32_bf16 v[24:27], v[224:227], v[80:83], v[24:27]
    v_mfma_f32_16x16x32_bf16 v[28:31], v[224:227], v[84:87], v[28:31]
    s_add_u32 s13, s63, 233472
    buffer_load_dwordx4 v[104:107], v5, s[68:71], s13 offen offset:0 sc1
    v_mfma_f32_16x16x32_bf16 v[40:43], v[228:231], v[80:83], v[40:43]
    v_mfma_f32_16x16x32_bf16 v[44:47], v[228:231], v[84:87], v[44:47]
    v_mfma_f32_16x16x32_bf16 v[56:59], v[232:235], v[80:83], v[56:59]
    s_add_u32 s14, s63, 290816
    buffer_load_dwordx4 v[108:111], v5, s[68:71], s14 offen offset:0 sc1
    v_mfma_f32_16x16x32_bf16 v[60:63], v[232:235], v[84:87], v[60:63]
    v_mfma_f32_16x16x32_bf16 v[72:75], v[236:239], v[80:83], v[72:75]
    v_mfma_f32_16x16x32_bf16 v[76:79], v[236:239], v[84:87], v[76:79]
    s_waitcnt vmcnt(4)
    v_mfma_f32_16x16x32_bf16 v[24:27], v[128:131], v[88:91], v[24:27]
    v_mfma_f32_16x16x32_bf16 v[28:31], v[128:131], v[92:95], v[28:31]
    buffer_load_dwordx4 v[112:115], v5, s[68:71], s13 offen offset:1024 sc1
    v_mfma_f32_16x16x32_bf16 v[40:43], v[132:135], v[88:91], v[40:43]
    v_mfma_f32_16x16x32_bf16 v[44:47], v[132:135], v[92:95], v[44:47]
    v_mfma_f32_16x16x32_bf16 v[56:59], v[136:139], v[88:91], v[56:59]
    buffer_load_dwordx4 v[116:119], v5, s[68:71], s14 offen offset:1024 sc1
    v_mfma_f32_16x16x32_bf16 v[60:63], v[136:139], v[92:95], v[60:63]
    v_mfma_f32_16x16x32_bf16 v[72:75], v[140:143], v[88:91], v[72:75]
    v_mfma_f32_16x16x32_bf16 v[76:79], v[140:143], v[92:95], v[76:79]
    ds_write_b128 v15, v[16:19] offset:0
    ds_write_b128 v15, v[32:35] offset:1024
    ds_write_b128 v15, v[48:51] offset:2048
    ds_write_b128 v15, v[64:67] offset:3072
    ds_write_b128 v15, v[20:23] offset:4096
    ds_write_b128 v15, v[36:39] offset:5120
    ds_write_b128 v15, v[52:55] offset:6144
    ds_write_b128 v15, v[68:71] offset:7168
    s_waitcnt vmcnt(4)
    v_mfma_f32_16x16x32_bf16 v[24:27], v[144:147], v[96:99], v[24:27]
    v_mfma_f32_16x16x32_bf16 v[28:31], v[144:147], v[100:103], v[28:31]
    buffer_load_dwordx4 v[120:123], v5, s[68:71], s13 offen offset:2048 sc1
    v_mfma_f32_16x16x32_bf16 v[40:43], v[148:151], v[96:99], v[40:43]
    v_mfma_f32_16x16x32_bf16 v[44:47], v[148:151], v[100:103], v[44:47]
    v_mfma_f32_16x16x32_bf16 v[56:59], v[152:155], v[96:99], v[56:59]
    buffer_load_dwordx4 v[124:127], v5, s[68:71], s14 offen offset:2048 sc1
    v_mfma_f32_16x16x32_bf16 v[60:63], v[152:155], v[100:103], v[60:63]
    v_mfma_f32_16x16x32_bf16 v[72:75], v[156:159], v[96:99], v[72:75]
    v_mfma_f32_16x16x32_bf16 v[76:79], v[156:159], v[100:103], v[76:79]
    s_waitcnt vmcnt(4)
    v_mfma_f32_16x16x32_bf16 v[24:27], v[160:163], v[104:107], v[24:27]
    v_mfma_f32_16x16x32_bf16 v[28:31], v[160:163], v[108:111], v[28:31]
    v_mfma_f32_16x16x32_bf16 v[40:43], v[164:167], v[104:107], v[40:43]
    v_mfma_f32_16x16x32_bf16 v[44:47], v[164:167], v[108:111], v[44:47]
    v_mfma_f32_16x16x32_bf16 v[56:59], v[168:171], v[104:107], v[56:59]
    v_mfma_f32_16x16x32_bf16 v[60:63], v[168:171], v[108:111], v[60:63]
    v_mfma_f32_16x16x32_bf16 v[72:75], v[172:175], v[104:107], v[72:75]
    v_mfma_f32_16x16x32_bf16 v[76:79], v[172:175], v[108:111], v[76:79]
    s_waitcnt vmcnt(2)
    v_mfma_f32_16x16x32_bf16 v[24:27], v[176:179], v[112:115], v[24:27]
    v_mfma_f32_16x16x32_bf16 v[28:31], v[176:179], v[116:119], v[28:31]
    v_mfma_f32_16x16x32_bf16 v[40:43], v[180:183], v[112:115], v[40:43]
    v_mfma_f32_16x16x32_bf16 v[44:47], v[180:183], v[116:119], v[44:47]
    v_mfma_f32_16x16x32_bf16 v[56:59], v[184:187], v[112:115], v[56:59]
    v_mfma_f32_16x16x32_bf16 v[60:63], v[184:187], v[116:119], v[60:63]
    v_mfma_f32_16x16x32_bf16 v[72:75], v[188:191], v[112:115], v[72:75]
    v_mfma_f32_16x16x32_bf16 v[76:79], v[188:191], v[116:119], v[76:79]
    s_waitcnt vmcnt(0)
    v_mfma_f32_16x16x32_bf16 v[24:27], v[192:195], v[120:123], v[24:27]
    v_mfma_f32_16x16x32_bf16 v[28:31], v[192:195], v[124:127], v[28:31]
    v_mfma_f32_16x16x32_bf16 v[40:43], v[196:199], v[120:123], v[40:43]
    v_mfma_f32_16x16x32_bf16 v[44:47], v[196:199], v[124:127], v[44:47]
    v_mfma_f32_16x16x32_bf16 v[56:59], v[200:203], v[120:123], v[56:59]
    v_mfma_f32_16x16x32_bf16 v[60:63], v[200:203], v[124:127], v[60:63]
    v_mfma_f32_16x16x32_bf16 v[72:75], v[204:207], v[120:123], v[72:75]
    v_mfma_f32_16x16x32_bf16 v[76:79], v[204:207], v[124:127], v[76:79]
    v_add_u32 v15, 0x10000, v15
    ds_write_b128 v15, v[24:27] offset:0
    s_nop 0
    ds_write_b128 v15, v[40:43] offset:1024
    s_nop 0
    ds_write_b128 v15, v[56:59] offset:2048
    s_nop 0
    ds_write_b128 v15, v[72:75] offset:3072
    ds_write_b128 v15, v[28:31] offset:4096
    ds_write_b128 v15, v[44:47] offset:5120
    ds_write_b128 v15, v[60:63] offset:6144
    ds_write_b128 v15, v[76:79] offset:7168
    s_lshr_b32 s9, s3, 2
    s_lshl_b32 s9, s9, 16
    s_and_b32 s13, s3, 3
    s_lshl_b32 s13, s13, 11
    s_add_u32 s9, s9, s13
    v_add_u32 v14, s9, v5
    v_lshlrev_b32 v10, 10, v4
    v_lshl_add_u32 v10, v3, 5, v10
    v_lshlrev_b32 v0, 16, v0
    v_lshlrev_b32 v1, 16, v1
    v_lshlrev_b32 v2, 16, v2
    v_lshlrev_b32 v6, 16, v6
    v_lshlrev_b32 v9, 16, v9
    v_lshlrev_b32 v11, 16, v11
    v_lshlrev_b32 v12, 16, v12
    v_lshlrev_b32 v13, 16, v13
    s_waitcnt lgkmcnt(0)
    s_barrier
    ds_read_b128 v[80:83], v14 offset:0
    ds_read_b128 v[84:87], v14 offset:1024
    ds_read_b128 v[88:91], v14 offset:8192
    ds_read_b128 v[92:95], v14 offset:9216
    ds_read_b128 v[96:99], v14 offset:16384
    ds_read_b128 v[100:103], v14 offset:17408
    ds_read_b128 v[104:107], v14 offset:24576
    ds_read_b128 v[108:111], v14 offset:25600
    ds_read_b128 v[112:115], v14 offset:32768
    ds_read_b128 v[116:119], v14 offset:33792
    ds_read_b128 v[120:123], v14 offset:40960
    ds_read_b128 v[124:127], v14 offset:41984
    ds_read_b128 v[128:131], v14 offset:49152
    ds_read_b128 v[132:135], v14 offset:50176
    ds_read_b128 v[136:139], v14 offset:57344
    ds_read_b128 v[140:143], v14 offset:58368
    s_waitcnt lgkmcnt(12)
    v_add_f32 v80, v80, v88
    v_add_f32 v81, v81, v89
    v_add_f32 v82, v82, v90
    v_add_f32 v83, v83, v91
    v_add_f32 v84, v84, v92
    v_add_f32 v85, v85, v93
    v_add_f32 v86, v86, v94
    v_add_f32 v87, v87, v95
    s_waitcnt lgkmcnt(10)
    v_add_f32 v80, v80, v96
    v_add_f32 v81, v81, v97
    v_add_f32 v82, v82, v98
    v_add_f32 v83, v83, v99
    v_add_f32 v84, v84, v100
    v_add_f32 v85, v85, v101
    v_add_f32 v86, v86, v102
    v_add_f32 v87, v87, v103
    s_waitcnt lgkmcnt(8)
    v_add_f32 v80, v80, v104
    v_add_f32 v81, v81, v105
    v_add_f32 v82, v82, v106
    v_add_f32 v83, v83, v107
    v_add_f32 v84, v84, v108
    v_add_f32 v85, v85, v109
    v_add_f32 v86, v86, v110
    v_add_f32 v87, v87, v111
    s_waitcnt lgkmcnt(6)
    v_add_f32 v80, v80, v112
    v_add_f32 v81, v81, v113
    v_add_f32 v82, v82, v114
    v_add_f32 v83, v83, v115
    v_add_f32 v84, v84, v116
    v_add_f32 v85, v85, v117
    v_add_f32 v86, v86, v118
    v_add_f32 v87, v87, v119
    s_waitcnt lgkmcnt(4)
    v_add_f32 v80, v80, v120
    v_add_f32 v81, v81, v121
    v_add_f32 v82, v82, v122
    v_add_f32 v83, v83, v123
    v_add_f32 v84, v84, v124
    v_add_f32 v85, v85, v125
    v_add_f32 v86, v86, v126
    v_add_f32 v87, v87, v127
    s_waitcnt lgkmcnt(2)
    v_add_f32 v80, v80, v128
    v_add_f32 v81, v81, v129
    v_add_f32 v82, v82, v130
    v_add_f32 v83, v83, v131
    v_add_f32 v84, v84, v132
    v_add_f32 v85, v85, v133
    v_add_f32 v86, v86, v134
    v_add_f32 v87, v87, v135
    s_waitcnt lgkmcnt(0)
    v_add_f32 v80, v80, v136
    v_add_f32 v81, v81, v137
    v_add_f32 v82, v82, v138
    v_add_f32 v83, v83, v139
    v_add_f32 v84, v84, v140
    v_add_f32 v85, v85, v141
    v_add_f32 v86, v86, v142
    v_add_f32 v87, v87, v143
    v_cvt_pk_bf16_f32 v88, v80, v81
    v_cvt_pk_bf16_f32 v89, v82, v83
    v_cvt_pk_bf16_f32 v90, v84, v85
    v_cvt_pk_bf16_f32 v91, v86, v87
    v_and_b32 v81, 0xffff0000, v88
    v_lshlrev_b32 v80, 16, v88
    v_and_b32 v83, 0xffff0000, v89
    v_lshlrev_b32 v82, 16, v89
    v_and_b32 v85, 0xffff0000, v90
    v_lshlrev_b32 v84, 16, v90
    v_and_b32 v87, 0xffff0000, v91
    v_lshlrev_b32 v86, 16, v91
    v_add_f32 v80, v80, v0
    v_add_f32 v81, v81, v1
    v_add_f32 v82, v82, v2
    v_add_f32 v83, v83, v6
    v_add_f32 v84, v84, v9
    v_add_f32 v85, v85, v11
    v_add_f32 v86, v86, v12
    v_add_f32 v87, v87, v13
    v_cvt_pk_bf16_f32 v88, v80, v81
    v_cvt_pk_bf16_f32 v89, v82, v83
    v_cvt_pk_bf16_f32 v90, v84, v85
    v_cvt_pk_bf16_f32 v91, v86, v87
    buffer_store_dwordx4 v[88:91], v10, s[48:51], s64 offen
    s_nop 1
KB_END:
    s_endpgm
.fill 2304, 4, 0xBF800000
.section .rodata,"a"
.p2align 6
.amdhsa_kernel ka_ssm_kernel
  .amdhsa_next_free_vgpr 128
  .amdhsa_next_free_sgpr 80
  .amdhsa_accum_offset 128
  .amdhsa_group_segment_fixed_size 0
  .amdhsa_kernarg_size 112
  .amdhsa_user_sgpr_count 2
  .amdhsa_user_sgpr_kernarg_segment_ptr 1
  .amdhsa_system_sgpr_workgroup_id_x 1
  .amdhsa_float_denorm_mode_32 3
  .amdhsa_float_denorm_mode_16_64 3
.end_amdhsa_kernel
.p2align 6
.amdhsa_kernel kb_mlp_kernel
  .amdhsa_next_free_vgpr 256
  .amdhsa_next_free_sgpr 80
  .amdhsa_accum_offset 256
  .amdhsa_group_segment_fixed_size 0
  .amdhsa_kernarg_size 112
  .amdhsa_user_sgpr_count 2
  .amdhsa_user_sgpr_kernarg_segment_ptr 1
  .amdhsa_system_sgpr_workgroup_id_x 1
  .amdhsa_float_denorm_mode_32 3
  .amdhsa_float_denorm_mode_16_64 3
.end_amdhsa_kernel
```
